```python
import torch

def _softmax(x, axis=-1):
    return torch.softmax(x, dim=axis)

def _gelu(x):
    return torch.nn.functional.gelu(x, approximate='tanh')

def _silu(x):
    return torch.nn.functional.silu(x)

def _sigmoid(x):
    return torch.sigmoid(x)

def _layernorm(x, axis=-1, eps=1e-05):
    m = x.mean(dim=axis, keepdim=True)
    v = x.var(dim=axis, keepdim=True, unbiased=False)
    return (x - m) / torch.sqrt(v + eps)

def _scatter_add(tgt, idx, src, axis=0):
    return tgt.clone().index_add_(axis, idx, src)

def _segment_sum(src, seg, n):
    out = torch.zeros((n,) + src.shape[1:], dtype=src.dtype)
    return out.index_add_(0, seg, src)

def _pad(x, pw):
    flat = tuple((v for pair in reversed(pw) for v in pair))
    return torch.nn.functional.pad(x, flat)
kernel_name = 'standalone__swin_window_attn__vision'

def setup_inputs():

    _w = lambda a: (lambda t: t.to(torch.bfloat16) if t.is_floating_point() else t)(torch.as_tensor(a))
    H = W = 512 // 7 * 7
    C, win = (96, 7)
    return {'x': _w((lambda *s: torch.randn(*s, dtype=torch.bfloat16) * 0.4)(1, H, W, C)), 'wqkv': _w((lambda *s: torch.randn(*s, dtype=torch.bfloat16) * 0.4)(C, 3 * C)), 'wo': _w((lambda *s: torch.randn(*s, dtype=torch.bfloat16) * 0.05)(C, C))}

def reference(x, wqkv, wo):
    B, H, W, C = x.shape
    win = 7
    nh, nw = (H // win, W // win)
    xw = (lambda x, *d: x.permute(*d))(x.reshape(B, nh, win, nw, win, C), 0, 1, 3, 2, 4, 5)
    xw = xw.reshape(B * nh * nw, win * win, C)
    qkv = xw @ wqkv
    q, k, v = (qkv[..., :C].clone(), qkv[..., C:2 * C].clone(), qkv[..., 2 * C:].clone())
    scale = C ** (-0.5)
    p = _softmax(torch.einsum('bqc,bkc->bqk', q, k) * scale, axis=-1)
    o = torch.einsum('bqk,bkc->bqc', p, v) @ wo
    o = (lambda x, *d: x.permute(*d))(o.reshape(B, nh, nw, win, win, C), 0, 1, 3, 2, 4, 5)
    return o.reshape(B, H, W, C)
```

```asm
; @launch grid=(256,1,1) block=(512,1,1) lds=161280
.amdgcn_target "amdgcn-amd-amdhsa--gfx950"
.text
.p2align 12
.globl standalone__swin_window_attn__vision_kernel
.p2align 8
.type standalone__swin_window_attn__vision_kernel,@function
standalone__swin_window_attn__vision_kernel:
    s_cmp_ge_u32 s2, 256
    s_cbranch_scc1 L_end
    s_load_dwordx8 s[4:11], s[0:1], 0
    s_getpc_b64 s[26:27]
    v_mul_u32_u24 v2, 28, v0
    v_mov_b32 v3, s27
    v_add_co_u32 v2, vcc, s26, v2
    s_nop 1
    v_addc_co_u32 v3, vcc, 0, v3, vcc
    global_load_dword v255, v[2:3], off
    v_lshrrev_b32 v1, 6, v0
    v_and_b32 v4, 255, v0
    v_and_b32 v0, 63, v0
    v_readfirstlane_b32 s28, v1
    s_and_b32 s49, s2, 7
    s_mul_i32 s49, s49, 128
    s_lshr_b32 s53, s2, 3
    s_mul_i32 s53, s53, 4
    s_add_u32 s49, s49, s53
    s_mov_b32 s14, 50135232
    s_mov_b32 s15, 0x20000
    s_mov_b32 s22, 55296
    s_mov_b32 s23, 0x20000
    v_lshlrev_b32 v6, 4, v0
    s_and_b32 s48, s28, 3
    s_cmp_lt_u32 s28, 4
    s_cbranch_scc1 L_c1
    s_setprio 3
    v_and_b32 v5, 60, v0
    v_mov_b32 v7, 0
    ds_write_b32 v5, v7 offset:37216
    v_add_u32 v5, 0, v0
    v_mul_u32_u24 v7, 2731, v5
    v_lshrrev_b32 v7, 16, v7
    v_mul_u32_u24 v1, 24, v7
    v_sub_u32 v5, v5, v1
    v_and_b32 v1, 2, v7
    v_lshlrev_b32 v1, 1, v1
    v_xor_b32 v5, v5, v1
    v_mul_u32_u24 v7, 576, v7
    v_lshl_add_u32 v240, v5, 4, v7
    v_add_u32 v5, 64, v0
    v_mul_u32_u24 v7, 2731, v5
    v_lshrrev_b32 v7, 16, v7
    v_mul_u32_u24 v1, 24, v7
    v_sub_u32 v5, v5, v1
    v_and_b32 v1, 2, v7
    v_lshlrev_b32 v1, 1, v1
    v_xor_b32 v5, v5, v1
    v_mul_u32_u24 v7, 576, v7
    v_lshl_add_u32 v241, v5, 4, v7
    v_subrev_u32 v241, 1024, v241
    v_add_u32 v5, 128, v0
    v_mul_u32_u24 v7, 2731, v5
    v_lshrrev_b32 v7, 16, v7
    v_mul_u32_u24 v1, 24, v7
    v_sub_u32 v5, v5, v1
    v_and_b32 v1, 2, v7
    v_lshlrev_b32 v1, 1, v1
    v_xor_b32 v5, v5, v1
    v_mul_u32_u24 v7, 576, v7
    v_lshl_add_u32 v242, v5, 4, v7
    v_subrev_u32 v242, 2048, v242
    s_mul_i32 s56, s48, 3
    s_mul_i32 s51, s56, 4608
    s_mul_i32 s50, s56, 3072
    s_add_u32 s50, s50, 87552
    s_waitcnt lgkmcnt(0)
    s_mov_b64 s[20:21], s[6:7]
    s_mov_b64 s[12:13], s[4:5]
    s_mov_b32 m0, s50
    s_lshl_b32 s52, s56, 4
    s_and_b32 s52, s52, 32
    v_xor_b32 v244, s52, v240
    buffer_load_dwordx4 v244, s[20:23], s51 offen lds
    v_xor_b32 v245, s52, v241
    buffer_load_dwordx4 v245, s[20:23], s51 offen offset:1024 lds
    v_xor_b32 v246, s52, v242
    buffer_load_dwordx4 v246, s[20:23], s51 offen offset:2048 lds
    s_add_u32 s56, s56, 1
    s_add_u32 s51, s51, 4608
    s_add_u32 s50, s50, 3072
    v_mul_u32_u24 v5, 0x1556, v4
    v_lshrrev_b32 v5, 16, v5
    v_mul_u32_u24 v7, 12, v5
    v_sub_u32 v4, v4, v7
    v_cmp_gt_u32 vcc, 20, v5
    v_lshrrev_b32 v7, 2, v5
    v_and_b32 v5, 3, v5
    v_lshl_add_u32 v5, v7, 10, v5
    v_mov_b32 v1, s49
    s_add_u32 s53, s2, 0
    v_mov_b32 v7, s53
    v_cndmask_b32 v7, v7, v1, vcc
    v_add_u32 v5, v7, v5
    s_mov_b32 s53, 58835169
    v_mul_hi_u32 v7, v5, s53
    v_mul_u32_u24 v5, 1344, v5
    v_lshl_add_u32 v4, v4, 4, v5
    s_mov_b32 s53, 588672
    v_mad_u32_u24 v4, v7, s53, v4
    s_lshl_b32 s54, s48, 10
    s_add_u32 s54, s54, 37376
    s_mov_b32 s55, 589824
    s_mov_b32 m0, s54
    s_nop 0
    buffer_load_dwordx4 v4, s[12:15], s55 offen lds
    s_mov_b32 m0, s50
    s_lshl_b32 s52, s56, 4
    s_and_b32 s52, s52, 32
    v_xor_b32 v244, s52, v240
    buffer_load_dwordx4 v244, s[20:23], s51 offen lds
    v_xor_b32 v245, s52, v241
    buffer_load_dwordx4 v245, s[20:23], s51 offen offset:1024 lds
    v_xor_b32 v246, s52, v242
    buffer_load_dwordx4 v246, s[20:23], s51 offen offset:2048 lds
    s_add_u32 s56, s56, 1
    s_add_u32 s51, s51, 4608
    s_add_u32 s50, s50, 3072
    s_mov_b32 m0, s50
    s_lshl_b32 s52, s56, 4
    s_and_b32 s52, s52, 32
    v_xor_b32 v244, s52, v240
    buffer_load_dwordx4 v244, s[20:23], s51 offen lds
    v_xor_b32 v245, s52, v241
    buffer_load_dwordx4 v245, s[20:23], s51 offen offset:1024 lds
    v_xor_b32 v246, s52, v242
    buffer_load_dwordx4 v246, s[20:23], s51 offen offset:2048 lds
    s_barrier
L_c1:
    s_add_u32 s57, s49, s48
    s_mul_hi_u32 s55, s57, 58835169
    s_mul_i32 s56, s55, 73
    s_sub_u32 s56, s57, s56
    s_mul_i32 s55, s55, 686784
    s_mul_i32 s56, s56, 1344
    s_add_u32 s60, s55, s56
    s_mul_i32 s61, s48, 9216
    s_add_u32 s61, s61, 50688
    s_add_u32 s62, s61, 4096
    s_add_u32 s63, s61, 8192
    v_xor_b32 v12, 0, v6
    v_xor_b32 v7, 16, v6
    v_cmp_le_u32 vcc, 48, v0
    s_nop 1
    v_cndmask_b32 v12, v12, v7, vcc
    v_xor_b32 v13, 16, v6
    v_xor_b32 v7, 32, v6
    v_cmp_le_u32 vcc, 32, v0
    s_nop 1
    v_cndmask_b32 v13, v13, v7, vcc
    v_xor_b32 v14, 32, v6
    v_xor_b32 v7, 48, v6
    v_cmp_le_u32 vcc, 16, v0
    s_nop 1
    v_cndmask_b32 v14, v14, v7, vcc
    v_add_u32 v20, 588800, v14
    v_add_u32 v19, 487936, v13
    v_add_u32 v18, 391168, v12
    v_add_u32 v17, 294400, v14
    v_add_u32 v16, 294400, v13
    v_add_u32 v15, 193536, v12
    v_add_u32 v14, 96768, v14
    s_lshl_b64 exec, -1, 20
    v_add_u32 v13, 96768, v13
    s_lshl_b64 exec, -1, 40
    v_add_u32 v14, 96768, v14
    s_lshl_b64 exec, -1, 60
    v_add_u32 v15, 96768, v15
    s_lshl_b64 exec, -1, 16
    v_add_u32 v17, 96768, v17
    s_lshl_b64 exec, -1, 36
    v_add_u32 v18, 96768, v18
    s_lshl_b64 exec, -1, 56
    v_add_u32 v19, 96768, v19
    s_mov_b64 exec, -1
    s_add_u32 s57, s57, 1024
    s_cmp_lt_u32 s28, 4
    s_cbranch_scc0 L_c2
    s_sub_u32 s57, s57, 1024
    s_waitcnt lgkmcnt(0)
    s_mov_b64 s[12:13], s[4:5]
    s_barrier
    s_mov_b32 m0, s61
    s_nop 0
    buffer_load_dwordx4 v12, s[12:15], s60 offen nt lds
    buffer_load_dwordx4 v13, s[12:15], s60 offen offset:1024 nt lds
    buffer_load_dwordx4 v14, s[12:15], s60 offen offset:2048 nt lds
    buffer_load_dwordx4 v15, s[12:15], s60 offen offset:3072 nt lds
    s_mov_b32 m0, s62
    s_nop 0
    buffer_load_dwordx4 v16, s[12:15], s60 offen nt lds
    buffer_load_dwordx4 v17, s[12:15], s60 offen offset:1024 nt lds
    buffer_load_dwordx4 v18, s[12:15], s60 offen offset:2048 nt lds
    buffer_load_dwordx4 v19, s[12:15], s60 offen offset:3072 nt lds
    s_mov_b32 m0, s63
    s_nop 0
    buffer_load_dwordx4 v20, s[12:15], s60 offen nt lds
L_c2:
    v_and_b32 v1, 15, v0
    v_lshrrev_b32 v2, 4, v0
    v_lshrrev_b32 v3, 2, v1
    v_and_b32 v21, 3, v0
    s_mul_hi_u32 s55, s57, 58835169
    s_mul_i32 s56, s55, 73
    s_sub_u32 s56, s57, s56
    s_mul_i32 s55, s55, 686784
    s_mul_i32 s56, s56, 1344
    s_add_u32 s31, s55, s56
    s_add_u32 s57, s57, 2048
    s_mul_hi_u32 s55, s57, 58835169
    s_mul_i32 s56, s55, 73
    s_sub_u32 s56, s57, s56
    s_mul_i32 s55, s55, 686784
    s_mul_i32 s56, s56, 1344
    s_add_u32 s32, s55, s56
    s_add_u32 s57, s57, 2048
    s_add_u32 s55, s2, 5120
    s_min_u32 s55, s55, 5328
    s_cmp_lt_u32 s28, 4
    s_cselect_b32 s57, s57, s55
    s_cselect_b32 s30, 3, 2
    s_cselect_b32 s25, 1, 2
    s_mov_b32 s47, 0x249269
    s_cselect_b32 s47, 0x2cb2cb, s47
    s_mul_i32 s53, s48, 6
    s_lshr_b32 s47, s47, s53
    s_mov_b32 s21, s30
    s_mul_hi_u32 s55, s57, 58835169
    s_mul_i32 s56, s55, 73
    s_sub_u32 s56, s57, s56
    s_mul_i32 s55, s55, 686784
    s_mul_i32 s56, s56, 1344
    s_add_u32 s33, s55, s56
    s_mul_i32 s44, s28, 9216
    s_add_u32 s44, s44, 50688
    s_add_u32 s45, s44, 4096
    s_add_u32 s46, s44, 8192
    s_mov_b32 s64, 124416
    s_lshl_b32 s22, s48, 2
    s_sub_u32 s23, s30, 2
    s_mov_b64 s[16:17], s[10:11]
    s_mov_b32 s18, 50135232
    s_mov_b32 s19, 0x20000
    v_lshl_add_u32 v5, v21, 2, v3
    v_mul_u32_u24 v5, 192, v5
    v_xor_b32 v7, v2, v21
    v_lshl_add_u32 v5, v7, 4, v5
    v_add_u32 v5, s44, v5
    v_mul_u32_u24 v8, 12, v1
    v_mul_u32_u24 v7, 192, v2
    v_add_u32 v8, v8, v7
    v_add_u32 v7, 96768, v8
    v_cmp_le_u32 vcc, 1, v2
    s_nop 1
    v_cndmask_b32 v9, v8, v7, vcc
    v_cmp_le_u32 vcc, 2, v2
    s_nop 1
    v_cndmask_b32 v10, v8, v7, vcc
    v_cmp_le_u32 vcc, 3, v2
    s_nop 1
    v_cndmask_b32 v11, v8, v7, vcc
    s_mul_i32 s53, s28, 192
    v_mul_u32_u24 v22, 1536, v3
    v_lshl_add_u32 v22, v2, 4, v22
    v_add_u32 v22, s53, v22
    v_mul_u32_u24 v23, 1536, v2
    v_mad_u32_u24 v23, v1, 12, v23
    v_add_u32 v23, s53, v23
    s_mov_b32 s29, 0
    s_mov_b32 s26, 0x000f000f
    s_mov_b32 s27, 0x000f000f
    s_mov_b32 s42, 0xffff
    s_mov_b32 s43, 0
    s_mov_b32 s24, 0x5d800000
    v_lshl_add_u32 v4, v3, 3, v21
    v_and_b32 v7, 2, v3
    v_xor_b32 v7, v7, v2
    v_mul_u32_u24 v166, 192, v1
    v_lshl_add_u32 v167, v2, 4, v166
    s_cmp_lt_u32 s28, 4
    s_cbranch_scc0 L_prepN
    v_mul_u32_u24 v4, 384, v4
    v_lshl_add_u32 v4, v7, 4, v4
    v_add_u32 v4, 87552, v4
    v_and_b32 v7, 2, v0
    v_lshlrev_b32 v7, 5, v7
    v_add_u32 v160, v4, v7
    v_sub_u32 v161, v4, v7
    s_lshr_b32 s53, s48, 1
    s_and_b32 s54, s48, 1
    s_mul_i32 s55, s53, 12288
    s_mul_i32 s56, s54, 1536
    s_add_u32 s55, s55, s56
    v_add_u32 v162, s55, v160
    v_add_u32 v163, s55, v161
    s_mul_i32 s55, s48, 3072
    v_add_u32 v164, s55, v6
    s_lshl_b32 s53, s53, 6
    s_lshl_b32 s54, s54, 3
    s_add_u32 s53, s53, s54
    s_add_u32 s53, s53, 41472
    v_add_u32 v166, s53, v167
    s_mov_b32 s59, 0x3e16c740
    v_mov_b32 v4, 0
L_pa:
    ds_read_b32 v7, v4 offset:37216
    s_waitcnt lgkmcnt(0)
    v_readfirstlane_b32 s53, v7
    s_nop 0
    s_cmp_lt_u32 s53, 4
    s_cbranch_scc1 L_pa
    ds_read_b128 v[120:123], v163 offset:192
    ds_read_b128 v[124:127], v162 offset:256
    ds_read_b128 v[128:131], v163 offset:320
    ds_read_b128 v[48:51], v160 offset:0
    ds_read_b128 v[52:55], v161 offset:64
    ds_read_b128 v[56:59], v160 offset:128
    ds_read_b128 v[60:63], v160 offset:1536
    ds_read_b128 v[64:67], v161 offset:1600
    ds_read_b128 v[68:71], v160 offset:1664
    ds_read_b128 v[72:75], v160 offset:12288
    ds_read_b128 v[76:79], v161 offset:12352
    ds_read_b128 v[80:83], v160 offset:12416
    ds_read_b128 v[84:87], v160 offset:13824
    ds_read_b128 v[88:91], v161 offset:13888
    s_waitcnt lgkmcnt(10)
    v_mfma_f32_16x16x32_bf16 v[144:147], v[48:51], v[120:123], 0
    ds_read_b128 v[92:95], v160 offset:13952
    ds_read_b128 v[96:99], v160 offset:24576
    s_waitcnt lgkmcnt(11)
    v_mfma_f32_16x16x32_bf16 v[144:147], v[52:55], v[124:127], v[144:147]
    ds_read_b128 v[100:103], v161 offset:24640
    ds_read_b128 v[104:107], v160 offset:24704
    s_waitcnt lgkmcnt(12)
    v_mfma_f32_16x16x32_bf16 v[144:147], v[56:59], v[128:131], v[144:147]
    ds_read_b128 v[108:111], v160 offset:26112
    ds_read_b128 v[112:115], v161 offset:26176
    s_waitcnt lgkmcnt(13)
    v_mfma_f32_16x16x32_bf16 v[148:151], v[60:63], v[120:123], 0
    ds_read_b128 v[116:119], v160 offset:26240
    ds_read_b128 v[204:207], v167 offset:37376
    s_waitcnt lgkmcnt(14)
    v_mfma_f32_16x16x32_bf16 v[148:151], v[64:67], v[124:127], v[148:151]
    ds_read_b128 v[208:211], v167 offset:37440
    s_waitcnt lgkmcnt(14)
    ds_read_b128 v[212:215], v167 offset:37504
    v_mfma_f32_16x16x32_bf16 v[148:151], v[68:71], v[128:131], v[148:151]
    s_waitcnt lgkmcnt(14)
    ds_read_b128 v[216:219], v167 offset:40448
    s_waitcnt lgkmcnt(14)
    ds_read_b128 v[220:223], v167 offset:40512
    v_mfma_f32_16x16x32_bf16 v[152:155], v[72:75], v[120:123], 0
    s_waitcnt lgkmcnt(14)
    ds_read_b128 v[224:227], v167 offset:40576
    s_waitcnt lgkmcnt(14)
    ds_read_b128 v[240:243], v163 offset:24768
    v_mfma_f32_16x16x32_bf16 v[152:155], v[76:79], v[124:127], v[152:155]
    s_waitcnt lgkmcnt(14)
    ds_read_b128 v[244:247], v162 offset:24832
    s_waitcnt lgkmcnt(14)
    ds_read_b128 v[248:251], v163 offset:24896
    v_mfma_f32_16x16x32_bf16 v[152:155], v[80:83], v[128:131], v[152:155]
    v_mul_f32 v144, s59, v144
    v_mul_f32 v145, s59, v145
    v_mfma_f32_16x16x32_bf16 v[156:159], v[84:87], v[120:123], 0
    v_mul_f32 v146, s59, v146
    v_mul_f32 v147, s59, v147
    v_mfma_f32_16x16x32_bf16 v[156:159], v[88:91], v[124:127], v[156:159]
    v_cvt_pk_bf16_f32 v132, v144, v145
    v_cvt_pk_bf16_f32 v133, v146, v147
    v_mfma_f32_16x16x32_bf16 v[156:159], v[92:95], v[128:131], v[156:159]
    v_mul_f32 v148, s59, v148
    v_mul_f32 v149, s59, v149
    s_waitcnt lgkmcnt(14)
    v_mfma_f32_16x16x32_bf16 v[144:147], v[96:99], v[120:123], 0
    v_mul_f32 v150, s59, v150
    v_mul_f32 v151, s59, v151
    s_waitcnt lgkmcnt(13)
    v_mfma_f32_16x16x32_bf16 v[144:147], v[100:103], v[124:127], v[144:147]
    v_cvt_pk_bf16_f32 v134, v148, v149
    v_cvt_pk_bf16_f32 v135, v150, v151
    s_waitcnt lgkmcnt(12)
    v_mfma_f32_16x16x32_bf16 v[144:147], v[104:107], v[128:131], v[144:147]
    ds_write_b128 v164, v[132:135] offset:0
    s_waitcnt lgkmcnt(12)
    v_mfma_f32_16x16x32_bf16 v[148:151], v[108:111], v[120:123], 0
    v_mul_f32 v152, s59, v152
    v_mul_f32 v153, s59, v153
    s_waitcnt lgkmcnt(11)
    v_mfma_f32_16x16x32_bf16 v[148:151], v[112:115], v[124:127], v[148:151]
    v_mul_f32 v154, s59, v154
    v_mul_f32 v155, s59, v155
    s_waitcnt lgkmcnt(10)
    v_mfma_f32_16x16x32_bf16 v[148:151], v[116:119], v[128:131], v[148:151]
    v_cvt_pk_bf16_f32 v136, v152, v153
    v_cvt_pk_bf16_f32 v137, v154, v155
    s_waitcnt lgkmcnt(9)
    v_mfma_f32_16x16x32_bf16 v[152:155], v[132:135], v[204:207], 0
    v_mul_f32 v156, s59, v156
    v_mul_f32 v157, s59, v157
    v_mul_f32 v158, s59, v158
    v_mul_f32 v159, s59, v159
    v_cvt_pk_bf16_f32 v138, v156, v157
    v_cvt_pk_bf16_f32 v139, v158, v159
    ds_write_b128 v164, v[136:139] offset:1024
    v_mul_f32 v144, s59, v144
    s_waitcnt lgkmcnt(9)
    v_mfma_f32_16x16x32_bf16 v[152:155], v[136:139], v[208:211], v[152:155]
    v_mul_f32 v145, s59, v145
    v_mul_f32 v146, s59, v146
    v_mul_f32 v147, s59, v147
    v_cvt_pk_bf16_f32 v140, v144, v145
    v_cvt_pk_bf16_f32 v141, v146, v147
    v_mul_f32 v148, s59, v148
    v_mul_f32 v149, s59, v149
    v_mul_f32 v150, s59, v150
    v_mul_f32 v151, s59, v151
    v_cvt_pk_bf16_f32 v142, v148, v149
    v_cvt_pk_bf16_f32 v143, v150, v151
    ds_write_b128 v164, v[140:143] offset:2048
    s_waitcnt lgkmcnt(9)
    v_mfma_f32_16x16x32_bf16 v[152:155], v[140:143], v[212:215], v[152:155]
    s_waitcnt lgkmcnt(8)
    v_mfma_f32_16x16x32_bf16 v[156:159], v[132:135], v[216:219], 0
    s_waitcnt lgkmcnt(7)
    v_mfma_f32_16x16x32_bf16 v[156:159], v[136:139], v[220:223], v[156:159]
    s_waitcnt lgkmcnt(6)
    v_mfma_f32_16x16x32_bf16 v[156:159], v[140:143], v[224:227], v[156:159]
    s_nop 1
    v_cvt_pk_bf16_f32 v152, v152, v153
    v_cvt_pk_bf16_f32 v153, v154, v155
    ds_write_b64 v166, v[152:153] offset:0
    s_nop 2
    v_cvt_pk_bf16_f32 v156, v156, v157
    v_cvt_pk_bf16_f32 v157, v158, v159
    s_mov_b32 exec_lo, 0x00ff00ff
    s_mov_b32 exec_hi, 0x00ff00ff
    ds_write_b64 v166, v[156:157] offset:3072
    s_mov_b64 exec, -1
    s_waitcnt lgkmcnt(0)
    s_bitcmp1_b32 s28, 1
    s_cbranch_scc1 L_pp0
    v_mfma_f32_16x16x32_bf16 v[144:147], v[48:51], v[240:243], 0
    v_mfma_f32_16x16x32_bf16 v[144:147], v[52:55], v[244:247], v[144:147]
    v_mfma_f32_16x16x32_bf16 v[144:147], v[56:59], v[248:251], v[144:147]
    v_mfma_f32_16x16x32_bf16 v[148:151], v[60:63], v[240:243], 0
    v_mfma_f32_16x16x32_bf16 v[148:151], v[64:67], v[244:247], v[148:151]
    v_mfma_f32_16x16x32_bf16 v[148:151], v[68:71], v[248:251], v[148:151]
    v_mfma_f32_16x16x32_bf16 v[152:155], v[72:75], v[240:243], 0
    v_mfma_f32_16x16x32_bf16 v[152:155], v[76:79], v[244:247], v[152:155]
    v_mfma_f32_16x16x32_bf16 v[152:155], v[80:83], v[248:251], v[152:155]
    v_mfma_f32_16x16x32_bf16 v[156:159], v[84:87], v[240:243], 0
    s_nop 0
    v_mul_f32 v144, s59, v144
    v_mfma_f32_16x16x32_bf16 v[156:159], v[88:91], v[244:247], v[156:159]
    v_mul_f32 v145, s59, v145
    v_mul_f32 v146, s59, v146
    v_mfma_f32_16x16x32_bf16 v[156:159], v[92:95], v[248:251], v[156:159]
    v_mul_f32 v147, s59, v147
    v_cvt_pk_bf16_f32 v132, v144, v145
    v_cvt_pk_bf16_f32 v133, v146, v147
    v_mfma_f32_16x16x32_bf16 v[144:147], v[96:99], v[240:243], 0
    v_mul_f32 v148, s59, v148
    v_mul_f32 v149, s59, v149
    v_mfma_f32_16x16x32_bf16 v[144:147], v[100:103], v[244:247], v[144:147]
    v_mul_f32 v150, s59, v150
    v_mul_f32 v151, s59, v151
    v_mfma_f32_16x16x32_bf16 v[144:147], v[104:107], v[248:251], v[144:147]
    v_cvt_pk_bf16_f32 v134, v148, v149
    v_cvt_pk_bf16_f32 v135, v150, v151
    v_mfma_f32_16x16x32_bf16 v[148:151], v[108:111], v[240:243], 0
    ds_write_b128 v164, v[132:135] offset:12288
    v_mfma_f32_16x16x32_bf16 v[148:151], v[112:115], v[244:247], v[148:151]
    v_mul_f32 v152, s59, v152
    v_mul_f32 v153, s59, v153
    v_mfma_f32_16x16x32_bf16 v[148:151], v[116:119], v[248:251], v[148:151]
    v_mul_f32 v154, s59, v154
    v_mul_f32 v155, s59, v155
    v_cvt_pk_bf16_f32 v136, v152, v153
    v_cvt_pk_bf16_f32 v137, v154, v155
    v_mfma_f32_16x16x32_bf16 v[152:155], v[132:135], v[204:207], 0
    v_mul_f32 v156, s59, v156
    v_mul_f32 v157, s59, v157
    v_mul_f32 v158, s59, v158
    v_mul_f32 v159, s59, v159
    v_cvt_pk_bf16_f32 v138, v156, v157
    v_cvt_pk_bf16_f32 v139, v158, v159
    ds_write_b128 v164, v[136:139] offset:13312
    v_mul_f32 v144, s59, v144
    v_mfma_f32_16x16x32_bf16 v[152:155], v[136:139], v[208:211], v[152:155]
    v_mul_f32 v145, s59, v145
    v_mul_f32 v146, s59, v146
    v_mul_f32 v147, s59, v147
    v_cvt_pk_bf16_f32 v140, v144, v145
    v_cvt_pk_bf16_f32 v141, v146, v147
    v_mul_f32 v148, s59, v148
    v_mul_f32 v149, s59, v149
    v_mul_f32 v150, s59, v150
    v_mul_f32 v151, s59, v151
    v_cvt_pk_bf16_f32 v142, v148, v149
    v_cvt_pk_bf16_f32 v143, v150, v151
    ds_write_b128 v164, v[140:143] offset:14336
    s_nop 0
    v_mfma_f32_16x16x32_bf16 v[152:155], v[140:143], v[212:215], v[152:155]
    v_mfma_f32_16x16x32_bf16 v[156:159], v[132:135], v[216:219], 0
    v_mfma_f32_16x16x32_bf16 v[156:159], v[136:139], v[220:223], v[156:159]
    v_mfma_f32_16x16x32_bf16 v[156:159], v[140:143], v[224:227], v[156:159]
    s_nop 4
    v_cvt_pk_bf16_f32 v152, v152, v153
    v_cvt_pk_bf16_f32 v153, v154, v155
    ds_write_b64 v166, v[152:153] offset:128
    v_cvt_pk_bf16_f32 v156, v156, v157
    v_cvt_pk_bf16_f32 v157, v158, v159
    s_mov_b32 exec_lo, 0x00ff00ff
    s_mov_b32 exec_hi, 0x00ff00ff
    ds_write_b64 v166, v[156:157] offset:3200
    s_mov_b64 exec, -1
    s_waitcnt lgkmcnt(0)
L_pp0:
    v_mov_b32 v4, 0
    v_mov_b32 v7, 1
    s_mov_b64 exec, 1
    ds_add_u32 v4, v7 offset:37220
    s_mov_b64 exec, -1
    v_mov_b32 v24, 0
    v_mov_b32 v25, 0
    v_mov_b32 v26, 0
    v_mov_b32 v27, 0
    v_mov_b32 v28, 0
    v_mov_b32 v29, 0
    v_mov_b32 v30, 0
    v_mov_b32 v31, 0
    v_mov_b32 v32, 0
    v_mov_b32 v33, 0
    v_mov_b32 v34, 0
    v_mov_b32 v35, 0
    v_mov_b32 v36, 0
    v_mov_b32 v37, 0
    v_mov_b32 v38, 0
    v_mov_b32 v39, 0
    v_mov_b32 v40, 0
    v_mov_b32 v41, 0
    v_mov_b32 v42, 0
    v_mov_b32 v43, 0
    v_mov_b32 v44, 0
    v_mov_b32 v45, 0
    v_mov_b32 v46, 0
    v_mov_b32 v47, 0
    v_mov_b32 v54, 0
    v_mov_b32 v55, 0
    v_mov_b32 v62, 0
    v_mov_b32 v63, 0
    v_mov_b32 v70, 0
    v_mov_b32 v71, 0
    v_mov_b32 v78, 0
    v_mov_b32 v79, 0
    v_mov_b32 v86, 0
    v_mov_b32 v87, 0
    v_mov_b32 v94, 0
    v_mov_b32 v95, 0
    v_mov_b32 v4, 0
L_pm:
    ds_read_b32 v7, v4 offset:37220
    s_waitcnt lgkmcnt(0)
    v_readfirstlane_b32 s53, v7
    s_nop 0
    s_cmp_lt_u32 s53, 4
    s_cbranch_scc1 L_pm
    s_waitcnt vmcnt(0)
    s_and_b32 s48, s47, 3
    s_lshr_b32 s47, s47, 2
    s_setprio 0
    s_cmp_eq_u32 s48, 0
    s_cbranch_scc1 L_npa
    s_setprio 1
    s_cmp_eq_u32 s48, 1
    s_cbranch_scc1 L_npa
    s_setprio 2
    s_cmp_eq_u32 s48, 2
    s_cbranch_scc1 L_npa
    s_setprio 3
L_npa:
L_join:
    s_cmp_eq_u32 s30, 3
    s_mov_b32 s53, 0x00110011
    s_cselect_b32 s53, 0x01110111, s53
    s_mul_i32 s55, s53, 7
    s_mov_b32 exec_lo, s55
    s_mov_b32 exec_hi, s55
    ds_read_b128 v[36:39], v22 offset:41472
    ds_read_b128 v[40:43], v22 offset:41536
    ds_read_b128 v[44:47], v22 offset:41600
    s_mov_b32 exec_lo, s53
    s_mov_b32 exec_hi, s53
    ds_read_b128 v[24:27], v22 offset:37376
    ds_read_b128 v[28:31], v22 offset:37440
    ds_read_b128 v[32:35], v22 offset:37504
    s_mov_b64 exec, -1
    ds_read_b128 v[96:99], v5 offset:0
    ds_read_b128 v[100:103], v5 offset:64
    ds_read_b128 v[104:107], v5 offset:128
    ds_read_b128 v[108:111], v5 offset:3072
    ds_read_b128 v[112:115], v5 offset:3136
    ds_read_b128 v[116:119], v5 offset:3200
    ds_read_b128 v[120:123], v5 offset:6144
    ds_read_b128 v[124:127], v5 offset:6208
    ds_read_b128 v[128:131], v5 offset:6272
    s_waitcnt lgkmcnt(9)
    v_mfma_f32_16x16x32_bf16 v[196:199], v[24:27], v[36:39], 0
    v_mfma_f32_16x16x32_bf16 v[196:199], v[28:31], v[40:43], v[196:199]
    v_mfma_f32_16x16x32_bf16 v[196:199], v[32:35], v[44:47], v[196:199]
    ds_read_b128 v[232:235], v6 offset:0
    ds_read_b128 v[236:239], v6 offset:1024
    ds_read_b128 v[240:243], v6 offset:2048
    s_mov_b32 s56, 0x22222222
    s_mov_b32 s58, 0x44444444
    s_mov_b32 s57, 0x22222222
    s_mov_b32 s59, 0x44444444
    s_mov_b32 vcc_lo, 0x88888888
    s_mov_b32 vcc_hi, 0x88888888
    v_mov_b32 v21, 0xff800000
    v_cndmask_b32 v193, 0, v21, vcc
    v_cndmask_b32 v194, 0, v21, vcc
    v_cndmask_b32 v195, 0, v21, vcc
    v_mov_b32_dpp v21, v196 quad_perm:[0,0,0,0] row_mask:0xf bank_mask:0xf
    v_cndmask_b32 v7, 0, v21, vcc
.p2align 6
L_loop:
    s_waitcnt lgkmcnt(0)
    s_cmp_eq_u32 s21, 1
    s_cbranch_scc1 L_nd1
    s_cmp_ge_u32 s25, 3
    s_cbranch_scc1 L_nd1
    s_mov_b32 m0, s44
    s_nop 0
    buffer_load_dwordx4 v12, s[12:15], s32 offen nt lds
    buffer_load_dwordx4 v13, s[12:15], s32 offen offset:1024 nt lds
    buffer_load_dwordx4 v14, s[12:15], s32 offen offset:2048 nt lds
    buffer_load_dwordx4 v15, s[12:15], s32 offen offset:3072 nt lds
    s_mov_b32 m0, s45
    s_nop 0
    buffer_load_dwordx4 v16, s[12:15], s32 offen nt lds
    buffer_load_dwordx4 v17, s[12:15], s32 offen offset:1024 nt lds
    buffer_load_dwordx4 v18, s[12:15], s32 offen offset:2048 nt lds
    buffer_load_dwordx4 v19, s[12:15], s32 offen offset:3072 nt lds
    s_mov_b32 m0, s46
    s_nop 0
    buffer_load_dwordx4 v20, s[12:15], s32 offen nt lds
L_nd1:
    s_cmp_eq_u32 s25, 2
    s_cbranch_scc1 L_oh1
L_rh1:
    v_mfma_f32_16x16x32_bf16 v[184:187], v[108:111], v[36:39], 0
    v_mov_b32 v4, 0xff800000
    v_mov_b32 v192, v193
    s_mov_b64 exec, s[42:43]
    v_mov_b32 v4, 0
    v_mov_b32 v192, v7
    s_mov_b64 exec, -1
    v_mfma_f32_16x16x32_bf16 v[184:187], v[112:115], v[40:43], v[184:187]
    ds_read_b128 v[244:247], v6 offset:3072
    ds_read_b128 v[248:251], v6 offset:4096
    v_mfma_f32_16x16x32_bf16 v[184:187], v[116:119], v[44:47], v[184:187]
    ds_read_b128 v[252:255], v6 offset:5120
    s_mov_b32 s34, s31
    v_mfma_f32_16x16x32_bf16 v[188:191], v[120:123], v[36:39], 0
    s_add_u32 s35, s31, 98112
    s_add_u32 s36, s31, 196224
    v_mfma_f32_16x16x32_bf16 v[188:191], v[124:127], v[40:43], v[188:191]
    s_add_u32 s37, s31, 294336
    s_add_u32 s38, s31, 392448
    v_mfma_f32_16x16x32_bf16 v[188:191], v[128:131], v[44:47], v[188:191]
    s_add_u32 s39, s31, 490560
    s_add_u32 s40, s31, 588672
    v_mfma_f32_16x16x32_bf16 v[180:183], v[96:99], v[36:39], v[192:195]
    s_mul_i32 s41, s29, 192
    s_sub_u32 s41, s40, s41
    v_mfma_f32_16x16x32_bf16 v[180:183], v[100:103], v[40:43], v[180:183]
    v_mfma_f32_16x16x32_bf16 v[180:183], v[104:107], v[44:47], v[180:183]
    v_mfma_f32_16x16x32_bf16 v[208:211], v[232:235], v[96:99], 0
    v_mfma_f32_16x16x32_bf16 v[208:211], v[236:239], v[100:103], v[208:211]
    v_mfma_f32_16x16x32_bf16 v[208:211], v[240:243], v[104:107], v[208:211]
    v_mfma_f32_16x16x32_bf16 v[212:215], v[232:235], v[108:111], 0
    v_mfma_f32_16x16x32_bf16 v[212:215], v[236:239], v[112:115], v[212:215]
    v_mfma_f32_16x16x32_bf16 v[212:215], v[240:243], v[116:119], v[212:215]
    v_mfma_f32_16x16x32_bf16 v[216:219], v[232:235], v[120:123], 0
    ds_read_b128 v[232:235], v6 offset:6144
    v_cndmask_b32 v180, v180, v184, s[56:57]
    v_mfma_f32_16x16x32_bf16 v[216:219], v[236:239], v[124:127], v[216:219]
    ds_read_b128 v[236:239], v6 offset:7168
    v_cvt_pk_bf16_f32 v48, v208, v209
    v_mfma_f32_16x16x32_bf16 v[216:219], v[240:243], v[128:131], v[216:219]
    ds_read_b128 v[240:243], v6 offset:8192
    v_cvt_pk_bf16_f32 v49, v210, v211
    s_waitcnt lgkmcnt(4)
    v_mfma_f32_16x16x32_bf16 v[220:223], v[244:247], v[96:99], 0
    s_cmp_ge_u32 s25, 3
    s_cbranch_scc1 L_oa
L_ra:
    v_mfma_f32_16x16x32_bf16 v[220:223], v[248:251], v[100:103], v[220:223]
    v_cvt_pk_bf16_f32 v72, v212, v213
    v_cvt_pk_bf16_f32 v73, v214, v215
    s_waitcnt lgkmcnt(3)
    v_mfma_f32_16x16x32_bf16 v[220:223], v[252:255], v[104:107], v[220:223]
    v_cvt_pk_bf16_f32 v196, v216, v217
    v_cvt_pk_bf16_f32 v197, v218, v219
    v_mfma_f32_16x16x32_bf16 v[224:227], v[244:247], v[108:111], 0
    v_cndmask_b32 v181, v181, v185, s[56:57]
    v_cndmask_b32 v182, v182, v186, s[56:57]
    v_mfma_f32_16x16x32_bf16 v[224:227], v[248:251], v[112:115], v[224:227]
    v_cndmask_b32 v183, v183, v187, s[56:57]
    v_cndmask_b32 v180, v180, v188, s[58:59]
    v_mfma_f32_16x16x32_bf16 v[224:227], v[252:255], v[116:119], v[224:227]
    v_cvt_pk_bf16_f32 v50, v220, v221
    v_cvt_pk_bf16_f32 v51, v222, v223
    v_mfma_f32_16x16x32_bf16 v[228:231], v[244:247], v[120:123], 0
    ds_read_b128 v[244:247], v6 offset:9216
    v_cndmask_b32 v181, v181, v189, s[58:59]
    v_mfma_f32_16x16x32_bf16 v[228:231], v[248:251], v[124:127], v[228:231]
    ds_read_b128 v[248:251], v6 offset:10240
    v_cndmask_b32 v182, v182, v190, s[58:59]
    v_mfma_f32_16x16x32_bf16 v[228:231], v[252:255], v[128:131], v[228:231]
    ds_read_b128 v[252:255], v6 offset:11264
    v_cvt_pk_bf16_f32 v74, v224, v225
    s_waitcnt lgkmcnt(3)
    v_mfma_f32_16x16x32_bf16 v[208:211], v[232:235], v[96:99], 0
    v_cvt_pk_bf16_f32 v75, v226, v227
    v_cndmask_b32 v183, v183, v191, s[58:59]
    v_mfma_f32_16x16x32_bf16 v[208:211], v[236:239], v[100:103], v[208:211]
    v_exp_f32 v180, v180
    v_mfma_f32_16x16x32_bf16 v[208:211], v[240:243], v[104:107], v[208:211]
    v_cvt_pk_bf16_f32 v198, v228, v229
    v_cvt_pk_bf16_f32 v199, v230, v231
    v_mfma_f32_16x16x32_bf16 v[212:215], v[232:235], v[108:111], 0
    v_exp_f32 v181, v181
    v_mfma_f32_16x16x32_bf16 v[212:215], v[236:239], v[112:115], v[212:215]
    v_exp_f32 v182, v182
    v_mfma_f32_16x16x32_bf16 v[212:215], v[240:243], v[116:119], v[212:215]
    v_add_f32 v21, v180, v181
    v_cvt_pk_bf16_f32 v56, v208, v209
    v_mfma_f32_16x16x32_bf16 v[216:219], v[232:235], v[120:123], 0
    ds_read_b128 v[232:235], v6 offset:12288
    v_cvt_pk_bf16_f32 v57, v210, v211
    v_mfma_f32_16x16x32_bf16 v[216:219], v[236:239], v[124:127], v[216:219]
    ds_read_b128 v[236:239], v6 offset:13312
    v_exp_f32 v183, v183
    v_mfma_f32_16x16x32_bf16 v[216:219], v[240:243], v[128:131], v[216:219]
    ds_read_b128 v[240:243], v6 offset:14336
    v_cvt_pk_bf16_f32 v80, v212, v213
    s_waitcnt lgkmcnt(3)
    v_mfma_f32_16x16x32_bf16 v[220:223], v[244:247], v[96:99], 0
    v_cvt_pk_bf16_f32 v81, v214, v215
    v_add_f32 v21, v21, v182
    v_mfma_f32_16x16x32_bf16 v[220:223], v[248:251], v[100:103], v[220:223]
    v_add_f32 v21, v21, v183
    v_mfma_f32_16x16x32_bf16 v[220:223], v[252:255], v[104:107], v[220:223]
    v_cvt_pk_bf16_f32 v200, v216, v217
    v_cvt_pk_bf16_f32 v201, v218, v219
    v_mfma_f32_16x16x32_bf16 v[224:227], v[244:247], v[108:111], 0
    v_add_f32_dpp v21, v21, v21 quad_perm:[1,0,3,2] row_mask:0xf bank_mask:0xf
    v_mfma_f32_16x16x32_bf16 v[224:227], v[248:251], v[112:115], v[224:227]
    s_nop 0
    v_add_f32_dpp v21, v21, v21 quad_perm:[2,3,0,1] row_mask:0xf bank_mask:0xf
    v_mfma_f32_16x16x32_bf16 v[224:227], v[252:255], v[116:119], v[224:227]
    v_cvt_pk_bf16_f32 v58, v220, v221
    v_cvt_pk_bf16_f32 v59, v222, v223
    v_mfma_f32_16x16x32_bf16 v[228:231], v[244:247], v[120:123], 0
    ds_read_b128 v[244:247], v6 offset:15360
    v_mov_b32 v2, v21
    v_mfma_f32_16x16x32_bf16 v[228:231], v[248:251], v[124:127], v[228:231]
    ds_read_b128 v[248:251], v6 offset:16384
    v_permlane32_swap_b32 v21, v2
    v_mfma_f32_16x16x32_bf16 v[228:231], v[252:255], v[128:131], v[228:231]
    ds_read_b128 v[252:255], v6 offset:17408
    v_cvt_pk_bf16_f32 v82, v224, v225
    s_waitcnt lgkmcnt(3)
    v_mfma_f32_16x16x32_bf16 v[208:211], v[232:235], v[96:99], 0
    v_cvt_pk_bf16_f32 v83, v226, v227
    v_add_f32 v21, v21, v2
    v_mfma_f32_16x16x32_bf16 v[208:211], v[236:239], v[100:103], v[208:211]
    v_mov_b32 v2, v21
    v_mfma_f32_16x16x32_bf16 v[208:211], v[240:243], v[104:107], v[208:211]
    v_cvt_pk_bf16_f32 v202, v228, v229
    v_cvt_pk_bf16_f32 v203, v230, v231
    v_mfma_f32_16x16x32_bf16 v[212:215], v[232:235], v[108:111], 0
    v_permlane16_swap_b32 v21, v2
    v_add_f32 v21, v21, v2
    v_mfma_f32_16x16x32_bf16 v[212:215], v[236:239], v[112:115], v[212:215]
    v_rcp_f32 v3, v21
    v_mfma_f32_16x16x32_bf16 v[212:215], v[240:243], v[116:119], v[212:215]
    v_cvt_pk_bf16_f32 v64, v208, v209
    v_cvt_pk_bf16_f32 v65, v210, v211
    v_mfma_f32_16x16x32_bf16 v[216:219], v[232:235], v[120:123], 0
    v_cndmask_b32 v3, 0, v3, s[26:27]
    v_mul_f32 v180, v180, v3
    v_mfma_f32_16x16x32_bf16 v[216:219], v[236:239], v[124:127], v[216:219]
    v_mul_f32 v181, v181, v3
    v_mul_f32 v182, v182, v3
    v_mfma_f32_16x16x32_bf16 v[216:219], v[240:243], v[128:131], v[216:219]
    v_cvt_pk_bf16_f32 v88, v212, v213
    v_cvt_pk_bf16_f32 v89, v214, v215
    s_waitcnt lgkmcnt(0)
    v_mfma_f32_16x16x32_bf16 v[220:223], v[244:247], v[96:99], 0
    v_mul_f32 v183, v183, v3
    v_cvt_pk_bf16_f32 v180, v180, v181
    v_mfma_f32_16x16x32_bf16 v[220:223], v[248:251], v[100:103], v[220:223]
    v_cvt_pk_bf16_f32 v181, v182, v183
    v_mov_b32_dpp v184, v180 quad_perm:[0,0,0,0] row_mask:0xf bank_mask:0xf
    v_mfma_f32_16x16x32_bf16 v[220:223], v[252:255], v[104:107], v[220:223]
    v_cvt_pk_bf16_f32 v204, v216, v217
    v_cvt_pk_bf16_f32 v205, v218, v219
    v_mfma_f32_16x16x32_bf16 v[224:227], v[244:247], v[108:111], 0
    v_mov_b32_dpp v185, v181 quad_perm:[0,0,0,0] row_mask:0xf bank_mask:0xf
    v_mov_b32_dpp v186, v180 quad_perm:[1,1,1,1] row_mask:0xf bank_mask:0xf
    v_mfma_f32_16x16x32_bf16 v[224:227], v[248:251], v[112:115], v[224:227]
    v_mov_b32_dpp v187, v181 quad_perm:[1,1,1,1] row_mask:0xf bank_mask:0xf
    v_mov_b32_dpp v188, v180 quad_perm:[2,2,2,2] row_mask:0xf bank_mask:0xf
    v_mfma_f32_16x16x32_bf16 v[224:227], v[252:255], v[116:119], v[224:227]
    v_cvt_pk_bf16_f32 v66, v220, v221
    v_cvt_pk_bf16_f32 v67, v222, v223
    v_mfma_f32_16x16x32_bf16 v[228:231], v[244:247], v[120:123], 0
    v_mov_b32_dpp v189, v181 quad_perm:[2,2,2,2] row_mask:0xf bank_mask:0xf
    v_mov_b32_dpp v190, v180 quad_perm:[3,3,3,3] row_mask:0xf bank_mask:0xf
    v_mfma_f32_16x16x32_bf16 v[228:231], v[248:251], v[124:127], v[228:231]
    v_mov_b32_dpp v191, v181 quad_perm:[3,3,3,3] row_mask:0xf bank_mask:0xf
    v_mfma_f32_16x16x32_bf16 v[228:231], v[252:255], v[128:131], v[228:231]
    v_cvt_pk_bf16_f32 v90, v224, v225
    v_cvt_pk_bf16_f32 v91, v226, v227
    v_mfma_f32_16x16x32_bf16 v[132:135], v[96:99], v[48:51], 0
    v_mfma_f32_16x16x32_bf16 v[136:139], v[108:111], v[48:51], 0
    v_mfma_f32_16x16x32_bf16 v[140:143], v[120:123], v[48:51], 0
    s_cmp_eq_u32 s25, 1
    s_cbranch_scc1 L_on
L_rn:
    v_mfma_f32_16x16x32_bf16 v[144:147], v[24:27], v[48:51], v[4:7]
    v_cvt_pk_bf16_f32 v206, v228, v229
    v_cvt_pk_bf16_f32 v207, v230, v231
    v_mfma_f32_16x16x32_bf16 v[132:135], v[100:103], v[56:59], v[132:135]
    v_mfma_f32_16x16x32_bf16 v[136:139], v[112:115], v[56:59], v[136:139]
    v_mfma_f32_16x16x32_bf16 v[140:143], v[124:127], v[56:59], v[140:143]
    v_mfma_f32_16x16x32_bf16 v[144:147], v[28:31], v[56:59], v[144:147]
    v_mfma_f32_16x16x32_bf16 v[132:135], v[104:107], v[64:67], v[132:135]
    v_mfma_f32_16x16x32_bf16 v[136:139], v[116:119], v[64:67], v[136:139]
    v_mfma_f32_16x16x32_bf16 v[140:143], v[128:131], v[64:67], v[140:143]
    v_mfma_f32_16x16x32_bf16 v[144:147], v[32:35], v[64:67], v[144:147]
    ds_read_b128 v[232:235], v6 offset:18432
    ds_read_b128 v[236:239], v6 offset:19456
    v_mfma_f32_16x16x32_bf16 v[148:151], v[96:99], v[72:75], 0
    ds_read_b128 v[240:243], v6 offset:20480
    ds_read_b128 v[244:247], v6 offset:21552
    v_mfma_f32_16x16x32_bf16 v[148:151], v[100:103], v[80:83], v[148:151]
    ds_read_b128 v[248:251], v6 offset:22576
    ds_read_b128 v[252:255], v6 offset:23600
    v_mfma_f32_16x16x32_bf16 v[148:151], v[104:107], v[88:91], v[148:151]
    v_exp_f32 v132, v132
    v_mfma_f32_16x16x32_bf16 v[152:155], v[108:111], v[72:75], 0
    v_exp_f32 v133, v133
    v_mfma_f32_16x16x32_bf16 v[152:155], v[112:115], v[80:83], v[152:155]
    v_exp_f32 v134, v134
    v_mfma_f32_16x16x32_bf16 v[152:155], v[116:119], v[88:91], v[152:155]
    v_add_f32 v147, v132, v133
    v_exp_f32 v135, v135
    v_mfma_f32_16x16x32_bf16 v[156:159], v[120:123], v[72:75], 0
    v_add_f32 v147, v147, v134
    v_exp_f32 v136, v136
    v_mfma_f32_16x16x32_bf16 v[156:159], v[124:127], v[80:83], v[156:159]
    v_add_f32 v147, v147, v135
    v_exp_f32 v137, v137
    v_mfma_f32_16x16x32_bf16 v[156:159], v[128:131], v[88:91], v[156:159]
    v_add_f32 v147, v147, v136
    v_exp_f32 v138, v138
    v_mfma_f32_16x16x32_bf16 v[160:163], v[24:27], v[72:75], v[4:7]
    v_add_f32 v147, v147, v137
    v_exp_f32 v139, v139
    v_mfma_f32_16x16x32_bf16 v[160:163], v[28:31], v[80:83], v[160:163]
    v_add_f32 v147, v147, v138
    v_exp_f32 v140, v140
    v_mfma_f32_16x16x32_bf16 v[160:163], v[32:35], v[88:91], v[160:163]
    v_add_f32 v147, v147, v139
    v_exp_f32 v141, v141
    v_mfma_f32_16x16x32_bf16 v[164:167], v[96:99], v[196:199], 0
    v_add_f32 v147, v147, v140
    v_exp_f32 v142, v142
    v_mfma_f32_16x16x32_bf16 v[164:167], v[100:103], v[200:203], v[164:167]
    v_add_f32 v147, v147, v141
    v_exp_f32 v143, v143
    v_mfma_f32_16x16x32_bf16 v[164:167], v[104:107], v[204:207], v[164:167]
    v_add_f32 v147, v147, v142
    v_exp_f32 v144, v144
    v_mfma_f32_16x16x32_bf16 v[168:171], v[108:111], v[196:199], 0
    v_add_f32 v147, v147, v143
    v_add_f32 v147, v147, v144
    v_mfma_f32_16x16x32_bf16 v[168:171], v[112:115], v[200:203], v[168:171]
    v_exp_f32 v148, v148
    v_mfma_f32_16x16x32_bf16 v[168:171], v[116:119], v[204:207], v[168:171]
    v_exp_f32 v149, v149
    v_mfma_f32_16x16x32_bf16 v[172:175], v[120:123], v[196:199], 0
    v_exp_f32 v150, v150
    v_mfma_f32_16x16x32_bf16 v[172:175], v[124:127], v[200:203], v[172:175]
    v_add_f32 v163, v148, v149
    v_exp_f32 v151, v151
    v_mfma_f32_16x16x32_bf16 v[172:175], v[128:131], v[204:207], v[172:175]
    v_add_f32 v163, v163, v150
    v_exp_f32 v152, v152
    v_mfma_f32_16x16x32_bf16 v[176:179], v[24:27], v[196:199], v[4:7]
    v_add_f32 v163, v163, v151
    v_exp_f32 v153, v153
    v_mfma_f32_16x16x32_bf16 v[176:179], v[28:31], v[200:203], v[176:179]
    v_add_f32 v163, v163, v152
    v_exp_f32 v154, v154
    v_mfma_f32_16x16x32_bf16 v[176:179], v[32:35], v[204:207], v[176:179]
    v_add_f32 v163, v163, v153
    v_exp_f32 v155, v155
    s_waitcnt lgkmcnt(3)
    v_mfma_f32_16x16x32_bf16 v[208:211], v[96:99], v[232:235], 0
    v_add_f32 v163, v163, v154
    v_exp_f32 v156, v156
    v_mfma_f32_16x16x32_bf16 v[208:211], v[100:103], v[236:239], v[208:211]
    v_add_f32 v163, v163, v155
    v_exp_f32 v157, v157
    v_mfma_f32_16x16x32_bf16 v[208:211], v[104:107], v[240:243], v[208:211]
    v_add_f32 v163, v163, v156
    v_exp_f32 v158, v158
    v_mfma_f32_16x16x32_bf16 v[212:215], v[108:111], v[232:235], 0
    v_add_f32 v163, v163, v157
    v_exp_f32 v159, v159
    v_mfma_f32_16x16x32_bf16 v[212:215], v[112:115], v[236:239], v[212:215]
    v_add_f32 v163, v163, v158
    v_exp_f32 v160, v160
    v_mfma_f32_16x16x32_bf16 v[212:215], v[116:119], v[240:243], v[212:215]
    v_cvt_pk_bf16_f32 v48, v208, v209
    v_cvt_pk_bf16_f32 v49, v210, v211
    v_mfma_f32_16x16x32_bf16 v[216:219], v[120:123], v[232:235], 0
    ds_read_b128 v[232:235], v6 offset:24672
    v_add_f32 v163, v163, v159
    v_mfma_f32_16x16x32_bf16 v[216:219], v[124:127], v[236:239], v[216:219]
    ds_read_b128 v[236:239], v6 offset:25696
    v_add_f32 v163, v163, v160
    v_mfma_f32_16x16x32_bf16 v[216:219], v[128:131], v[240:243], v[216:219]
    ds_read_b128 v[240:243], v6 offset:26720
    v_cvt_pk_bf16_f32 v50, v212, v213
    s_waitcnt lgkmcnt(3)
    v_mfma_f32_16x16x32_bf16 v[220:223], v[96:99], v[244:247], 0
    v_cvt_pk_bf16_f32 v51, v214, v215
    v_permlane32_swap_b32 v147, v163
    v_mfma_f32_16x16x32_bf16 v[220:223], v[100:103], v[248:251], v[220:223]
    v_add_f32 v147, v147, v163
    v_exp_f32 v164, v164
    v_mfma_f32_16x16x32_bf16 v[220:223], v[104:107], v[252:255], v[220:223]
    v_cvt_pk_bf16_f32 v52, v216, v217
    v_cvt_pk_bf16_f32 v53, v218, v219
    v_mfma_f32_16x16x32_bf16 v[224:227], v[108:111], v[244:247], 0
    v_exp_f32 v165, v165
    v_mfma_f32_16x16x32_bf16 v[224:227], v[112:115], v[248:251], v[224:227]
    v_exp_f32 v166, v166
    v_mfma_f32_16x16x32_bf16 v[224:227], v[116:119], v[252:255], v[224:227]
    v_add_f32 v179, v164, v165
    v_cvt_pk_bf16_f32 v56, v220, v221
    v_mfma_f32_16x16x32_bf16 v[228:231], v[120:123], v[244:247], 0
    ds_read_b128 v[244:247], v6 offset:27792
    v_cvt_pk_bf16_f32 v57, v222, v223
    v_mfma_f32_16x16x32_bf16 v[228:231], v[124:127], v[248:251], v[228:231]
    ds_read_b128 v[248:251], v6 offset:28816
    v_exp_f32 v167, v167
    v_mfma_f32_16x16x32_bf16 v[228:231], v[128:131], v[252:255], v[228:231]
    ds_read_b128 v[252:255], v6 offset:29840
    v_cvt_pk_bf16_f32 v58, v224, v225
    s_waitcnt lgkmcnt(3)
    v_mfma_f32_16x16x32_bf16 v[208:211], v[96:99], v[232:235], 0
    v_cvt_pk_bf16_f32 v59, v226, v227
    v_add_f32 v179, v179, v166
    v_mfma_f32_16x16x32_bf16 v[208:211], v[100:103], v[236:239], v[208:211]
    v_exp_f32 v168, v168
    v_mfma_f32_16x16x32_bf16 v[208:211], v[104:107], v[240:243], v[208:211]
    v_cvt_pk_bf16_f32 v60, v228, v229
    v_cvt_pk_bf16_f32 v61, v230, v231
    v_mfma_f32_16x16x32_bf16 v[212:215], v[108:111], v[232:235], 0
    v_add_f32 v179, v179, v167
    v_exp_f32 v169, v169
    v_mfma_f32_16x16x32_bf16 v[212:215], v[112:115], v[236:239], v[212:215]
    v_add_f32 v179, v179, v168
    v_exp_f32 v170, v170
    v_mfma_f32_16x16x32_bf16 v[212:215], v[116:119], v[240:243], v[212:215]
    v_cvt_pk_bf16_f32 v64, v208, v209
    v_cvt_pk_bf16_f32 v65, v210, v211
    v_mfma_f32_16x16x32_bf16 v[216:219], v[120:123], v[232:235], 0
    ds_read_b128 v[232:235], v6 offset:30912
    v_add_f32 v179, v179, v169
    v_mfma_f32_16x16x32_bf16 v[216:219], v[124:127], v[236:239], v[216:219]
    ds_read_b128 v[236:239], v6 offset:31936
    v_exp_f32 v171, v171
    v_mfma_f32_16x16x32_bf16 v[216:219], v[128:131], v[240:243], v[216:219]
    ds_read_b128 v[240:243], v6 offset:32960
    v_cvt_pk_bf16_f32 v66, v212, v213
    s_waitcnt lgkmcnt(3)
    v_mfma_f32_16x16x32_bf16 v[220:223], v[96:99], v[244:247], 0
    v_cvt_pk_bf16_f32 v67, v214, v215
    v_add_f32 v179, v179, v170
    v_mfma_f32_16x16x32_bf16 v[220:223], v[100:103], v[248:251], v[220:223]
    v_exp_f32 v172, v172
    v_mfma_f32_16x16x32_bf16 v[220:223], v[104:107], v[252:255], v[220:223]
    v_cvt_pk_bf16_f32 v68, v216, v217
    v_cvt_pk_bf16_f32 v69, v218, v219
    v_mfma_f32_16x16x32_bf16 v[224:227], v[108:111], v[244:247], 0
    v_add_f32 v179, v179, v171
    v_exp_f32 v173, v173
    v_mfma_f32_16x16x32_bf16 v[224:227], v[112:115], v[248:251], v[224:227]
    v_add_f32 v179, v179, v172
    v_exp_f32 v174, v174
    v_mfma_f32_16x16x32_bf16 v[224:227], v[116:119], v[252:255], v[224:227]
    v_cvt_pk_bf16_f32 v72, v220, v221
    v_cvt_pk_bf16_f32 v73, v222, v223
    v_mfma_f32_16x16x32_bf16 v[228:231], v[120:123], v[244:247], 0
    ds_read_b128 v[244:247], v6 offset:34032
    v_add_f32 v179, v179, v173
    v_mfma_f32_16x16x32_bf16 v[228:231], v[124:127], v[248:251], v[228:231]
    ds_read_b128 v[248:251], v6 offset:35056
    v_exp_f32 v175, v175
    v_mfma_f32_16x16x32_bf16 v[228:231], v[128:131], v[252:255], v[228:231]
    ds_read_b128 v[252:255], v6 offset:36080
    v_cvt_pk_bf16_f32 v74, v224, v225
    s_waitcnt lgkmcnt(3)
    v_mfma_f32_16x16x32_bf16 v[208:211], v[96:99], v[232:235], 0
    v_cvt_pk_bf16_f32 v75, v226, v227
    v_add_f32 v179, v179, v174
    v_mfma_f32_16x16x32_bf16 v[208:211], v[100:103], v[236:239], v[208:211]
    v_exp_f32 v176, v176
    v_mfma_f32_16x16x32_bf16 v[208:211], v[104:107], v[240:243], v[208:211]
    v_cvt_pk_bf16_f32 v76, v228, v229
    v_cvt_pk_bf16_f32 v77, v230, v231
    v_mfma_f32_16x16x32_bf16 v[212:215], v[108:111], v[232:235], 0
    v_add_f32 v179, v179, v175
    v_add_f32 v179, v179, v176
    v_mfma_f32_16x16x32_bf16 v[212:215], v[112:115], v[236:239], v[212:215]
    s_nop 0
    v_permlane32_swap_b32 v179, v21
    v_mfma_f32_16x16x32_bf16 v[212:215], v[116:119], v[240:243], v[212:215]
    v_cvt_pk_bf16_f32 v80, v208, v209
    v_cvt_pk_bf16_f32 v81, v210, v211
    v_mfma_f32_16x16x32_bf16 v[216:219], v[120:123], v[232:235], 0
    v_add_f32 v179, v179, v21
    v_mfma_f32_16x16x32_bf16 v[216:219], v[124:127], v[236:239], v[216:219]
    s_nop 0
    v_permlane16_swap_b32 v147, v179
    v_mfma_f32_16x16x32_bf16 v[216:219], v[128:131], v[240:243], v[216:219]
    v_cvt_pk_bf16_f32 v82, v212, v213
    v_cvt_pk_bf16_f32 v83, v214, v215
    s_waitcnt lgkmcnt(0)
    v_mfma_f32_16x16x32_bf16 v[220:223], v[96:99], v[244:247], 0
    v_add_f32 v147, v147, v179
    v_rcp_f32 v145, v147
    v_mfma_f32_16x16x32_bf16 v[220:223], v[100:103], v[248:251], v[220:223]
    v_max_f32 v1, v145, v147
    v_mov_b32 v177, v145
    v_mfma_f32_16x16x32_bf16 v[220:223], v[104:107], v[252:255], v[220:223]
    v_cvt_pk_bf16_f32 v84, v216, v217
    v_cvt_pk_bf16_f32 v85, v218, v219
    v_mfma_f32_16x16x32_bf16 v[224:227], v[108:111], v[244:247], 0
    v_permlane16_swap_b32 v145, v177
    v_mov_b32 v22, v177
    v_mfma_f32_16x16x32_bf16 v[224:227], v[112:115], v[248:251], v[224:227]
    v_mov_b32 v161, v145
    v_permlane32_swap_b32 v177, v22
    v_mfma_f32_16x16x32_bf16 v[224:227], v[116:119], v[252:255], v[224:227]
    v_cvt_pk_bf16_f32 v88, v220, v221
    v_cvt_pk_bf16_f32 v89, v222, v223
    v_mfma_f32_16x16x32_bf16 v[228:231], v[120:123], v[244:247], 0
    v_permlane32_swap_b32 v145, v161
    v_mul_f32 v132, v132, v145
    v_mfma_f32_16x16x32_bf16 v[228:231], v[124:127], v[248:251], v[228:231]
    v_mul_f32 v133, v133, v145
    v_cvt_pk_bf16_f32 v132, v132, v133
    v_mfma_f32_16x16x32_bf16 v[228:231], v[128:131], v[252:255], v[228:231]
    v_cvt_pk_bf16_f32 v90, v224, v225
    v_cvt_pk_bf16_f32 v91, v226, v227
    v_mfma_f32_16x16x32_bf16 v[196:199], v[184:187], v[48:51], 0
    v_mul_f32 v134, v134, v145
    v_mul_f32 v135, v135, v145
    v_mfma_f32_16x16x32_bf16 v[196:199], v[188:191], v[52:55], v[196:199]
    v_cvt_pk_bf16_f32 v133, v134, v135
    v_mul_f32 v136, v136, v145
    v_mfma_f32_16x16x32_bf16 v[200:203], v[184:187], v[56:59], 0
    v_cvt_pk_bf16_f32 v92, v228, v229
    v_cvt_pk_bf16_f32 v93, v230, v231
    v_mfma_f32_16x16x32_bf16 v[200:203], v[188:191], v[60:63], v[200:203]
    v_mul_f32 v137, v137, v145
    v_cvt_pk_bf16_f32 v134, v136, v137
    v_mfma_f32_16x16x32_bf16 v[204:207], v[184:187], v[64:67], 0
    v_mul_f32 v138, v138, v145
    v_mul_f32 v139, v139, v145
    v_mfma_f32_16x16x32_bf16 v[204:207], v[188:191], v[68:71], v[204:207]
    v_cvt_pk_bf16_f32 v135, v138, v139
    v_mul_f32 v140, v140, v145
    v_mfma_f32_16x16x32_bf16 v[244:247], v[184:187], v[72:75], 0
    v_mul_f32 v141, v141, v145
    v_cvt_pk_bf16_f32 v136, v140, v141
    v_mfma_f32_16x16x32_bf16 v[244:247], v[188:191], v[76:79], v[244:247]
    v_mul_f32 v142, v142, v145
    v_mul_f32 v143, v143, v145
    v_mfma_f32_16x16x32_bf16 v[248:251], v[184:187], v[80:83], 0
    v_cvt_pk_bf16_f32 v137, v142, v143
    v_mul_f32 v144, v144, v145
    v_mfma_f32_16x16x32_bf16 v[248:251], v[188:191], v[84:87], v[248:251]
    v_cvt_pk_bf16_f32 v138, v144, 0
    v_mov_b32 v139, 0
    v_mfma_f32_16x16x32_bf16 v[252:255], v[184:187], v[88:91], 0
    v_mul_f32 v148, v148, v161
    v_mul_f32 v149, v149, v161
    v_mfma_f32_16x16x32_bf16 v[252:255], v[188:191], v[92:95], v[252:255]
    v_cvt_pk_bf16_f32 v148, v148, v149
    v_mul_f32 v150, v150, v161
    v_mfma_f32_16x16x32_bf16 v[208:211], v[132:135], v[48:51], 0
    v_mul_f32 v151, v151, v161
    v_cvt_pk_bf16_f32 v149, v150, v151
    v_mfma_f32_16x16x32_bf16 v[208:211], v[136:139], v[52:55], v[208:211]
    v_mul_f32 v152, v152, v161
    v_mul_f32 v153, v153, v161
    v_mfma_f32_16x16x32_bf16 v[212:215], v[132:135], v[56:59], 0
    v_cvt_pk_bf16_f32 v150, v152, v153
    v_mul_f32 v154, v154, v161
    v_mfma_f32_16x16x32_bf16 v[212:215], v[136:139], v[60:63], v[212:215]
    v_mul_f32 v155, v155, v161
    v_cvt_pk_bf16_f32 v151, v154, v155
    v_mfma_f32_16x16x32_bf16 v[216:219], v[132:135], v[64:67], 0
    v_mul_f32 v156, v156, v161
    v_mul_f32 v157, v157, v161
    v_mfma_f32_16x16x32_bf16 v[216:219], v[136:139], v[68:71], v[216:219]
    v_cvt_pk_bf16_f32 v152, v156, v157
    v_mul_f32 v158, v158, v161
    v_mfma_f32_16x16x32_bf16 v[220:223], v[132:135], v[72:75], 0
    v_mul_f32 v159, v159, v161
    v_cvt_pk_bf16_f32 v153, v158, v159
    v_mfma_f32_16x16x32_bf16 v[220:223], v[136:139], v[76:79], v[220:223]
    v_mul_f32 v160, v160, v161
    v_cvt_pk_bf16_f32 v154, v160, 0
    v_mfma_f32_16x16x32_bf16 v[224:227], v[132:135], v[80:83], 0
    v_mov_b32 v155, 0
    v_mul_f32 v164, v164, v177
    v_mfma_f32_16x16x32_bf16 v[224:227], v[136:139], v[84:87], v[224:227]
    v_mul_f32 v165, v165, v177
    v_cvt_pk_bf16_f32 v164, v164, v165
    v_mfma_f32_16x16x32_bf16 v[228:231], v[132:135], v[88:91], 0
    v_mul_f32 v166, v166, v177
    v_mul_f32 v167, v167, v177
    v_mfma_f32_16x16x32_bf16 v[228:231], v[136:139], v[92:95], v[228:231]
    v_cvt_pk_bf16_f32 v165, v166, v167
    v_mul_f32 v168, v168, v177
    v_mul_f32 v169, v169, v177
    v_cvt_pk_bf16_f32 v166, v168, v169
    v_mul_f32 v170, v170, v177
    v_mul_f32 v171, v171, v177
    v_cvt_pk_bf16_f32 v167, v170, v171
    v_mul_f32 v172, v172, v177
    v_mul_f32 v173, v173, v177
    v_cvt_pk_bf16_f32 v168, v172, v173
    v_mul_f32 v174, v174, v177
    v_mul_f32 v175, v175, v177
    v_cvt_pk_bf16_f32 v169, v174, v175
    v_mul_f32 v176, v176, v177
    v_cvt_pk_bf16_f32 v170, v176, 0
    v_mov_b32 v171, 0
    v_cmp_nge_f32 vcc, s24, v1
    v_cvt_pk_bf16_f32 v180, v196, v200
    v_mfma_f32_16x16x32_bf16 v[196:199], v[148:151], v[48:51], 0
    v_cvt_pk_bf16_f32 v181, v204, v244
    v_cvt_pk_bf16_f32 v182, v248, v252
    v_mfma_f32_16x16x32_bf16 v[196:199], v[152:155], v[52:55], v[196:199]
    s_mov_b64 exec, s[42:43]
    buffer_store_dwordx3 v[180:182], v8, s[16:19], s41 offen offset:1152 sc1
    s_mov_b64 exec, -1
    v_mfma_f32_16x16x32_bf16 v[200:203], v[148:151], v[56:59], 0
    v_cvt_pk_bf16_f32 v140, v208, v212
    v_cvt_pk_bf16_f32 v141, v216, v220
    v_mfma_f32_16x16x32_bf16 v[200:203], v[152:155], v[60:63], v[200:203]
    v_cvt_pk_bf16_f32 v142, v224, v228
    buffer_store_dwordx3 v[140:142], v8, s[16:19], s34 offen sc1
    v_mfma_f32_16x16x32_bf16 v[204:207], v[148:151], v[64:67], 0
    v_cvt_pk_bf16_f32 v144, v209, v213
    v_cvt_pk_bf16_f32 v145, v217, v221
    v_mfma_f32_16x16x32_bf16 v[204:207], v[152:155], v[68:71], v[204:207]
    v_cvt_pk_bf16_f32 v146, v225, v229
    buffer_store_dwordx3 v[144:146], v11, s[16:19], s34 offen offset:768 sc1
    v_mfma_f32_16x16x32_bf16 v[244:247], v[148:151], v[72:75], 0
    v_cvt_pk_bf16_f32 v140, v210, v214
    v_cvt_pk_bf16_f32 v141, v218, v222
    v_mfma_f32_16x16x32_bf16 v[244:247], v[152:155], v[76:79], v[244:247]
    v_cvt_pk_bf16_f32 v142, v226, v230
    buffer_store_dwordx3 v[140:142], v8, s[16:19], s35 offen offset:192 sc1
    v_mfma_f32_16x16x32_bf16 v[248:251], v[148:151], v[80:83], 0
    v_cvt_pk_bf16_f32 v144, v211, v215
    v_cvt_pk_bf16_f32 v145, v219, v223
    v_mfma_f32_16x16x32_bf16 v[248:251], v[152:155], v[84:87], v[248:251]
    v_cvt_pk_bf16_f32 v146, v227, v231
    buffer_store_dwordx3 v[144:146], v10, s[16:19], s35 offen offset:960 sc1
    v_mfma_f32_16x16x32_bf16 v[252:255], v[148:151], v[88:91], 0
    v_cvt_pk_bf16_f32 v156, v196, v200
    v_cvt_pk_bf16_f32 v157, v204, v244
    v_mfma_f32_16x16x32_bf16 v[252:255], v[152:155], v[92:95], v[252:255]
    v_cvt_pk_bf16_f32 v160, v197, v201
    v_cvt_pk_bf16_f32 v161, v205, v245
    v_mfma_f32_16x16x32_bf16 v[208:211], v[164:167], v[48:51], 0
    v_cvt_pk_bf16_f32 v140, v198, v202
    v_cvt_pk_bf16_f32 v141, v206, v246
    v_mfma_f32_16x16x32_bf16 v[208:211], v[168:171], v[52:55], v[208:211]
    v_cvt_pk_bf16_f32 v144, v199, v203
    v_cvt_pk_bf16_f32 v145, v207, v247
    v_mfma_f32_16x16x32_bf16 v[212:215], v[164:167], v[56:59], 0
    s_cmp_eq_u32 s25, 1
    s_cbranch_scc1 L_oh2
L_rh2:
    v_mfma_f32_16x16x32_bf16 v[212:215], v[168:171], v[60:63], v[212:215]
    v_cvt_pk_bf16_f32 v158, v248, v252
    buffer_store_dwordx3 v[156:158], v8, s[16:19], s36 offen offset:384 sc1
    v_mfma_f32_16x16x32_bf16 v[216:219], v[164:167], v[64:67], 0
    v_cvt_pk_bf16_f32 v162, v249, v253
    buffer_store_dwordx3 v[160:162], v9, s[16:19], s36 offen offset:1152 sc1
    v_mfma_f32_16x16x32_bf16 v[216:219], v[168:171], v[68:71], v[216:219]
    v_cvt_pk_bf16_f32 v142, v250, v254
    buffer_store_dwordx3 v[140:142], v8, s[16:19], s37 offen offset:576 sc1
    v_mfma_f32_16x16x32_bf16 v[220:223], v[164:167], v[72:75], 0
    v_cvt_pk_bf16_f32 v146, v251, v255
    buffer_store_dwordx3 v[144:146], v8, s[16:19], s38 offen sc1
    v_mfma_f32_16x16x32_bf16 v[220:223], v[168:171], v[76:79], v[220:223]
    v_cvt_pk_bf16_f32 v172, v208, v212
    v_cvt_pk_bf16_f32 v176, v209, v213
    v_mfma_f32_16x16x32_bf16 v[224:227], v[164:167], v[80:83], 0
    v_cvt_pk_bf16_f32 v156, v210, v214
    v_cvt_pk_bf16_f32 v160, v211, v215
    v_mfma_f32_16x16x32_bf16 v[224:227], v[168:171], v[84:87], v[224:227]
    s_waitcnt vmcnt(9)
    ds_read_b128 v[96:99], v5 offset:0
    ds_read_b128 v[100:103], v5 offset:64
    v_mfma_f32_16x16x32_bf16 v[228:231], v[164:167], v[88:91], 0
    v_cvt_pk_bf16_f32 v173, v216, v220
    v_cvt_pk_bf16_f32 v177, v217, v221
    v_mfma_f32_16x16x32_bf16 v[228:231], v[168:171], v[92:95], v[228:231]
    v_cvt_pk_bf16_f32 v157, v218, v222
    v_cvt_pk_bf16_f32 v161, v219, v223
    ds_read_b128 v[104:107], v5 offset:128
    ds_read_b128 v[108:111], v5 offset:3072
    ds_read_b128 v[112:115], v5 offset:3136
    ds_read_b128 v[116:119], v5 offset:3200
    ds_read_b128 v[120:123], v5 offset:6144
    ds_read_b128 v[124:127], v5 offset:6208
    v_cvt_pk_bf16_f32 v174, v224, v228
    buffer_store_dwordx3 v[172:174], v11, s[16:19], s38 offen offset:768 sc1
    v_cvt_pk_bf16_f32 v178, v225, v229
    buffer_store_dwordx3 v[176:178], v8, s[16:19], s39 offen offset:192 sc1
    v_cvt_pk_bf16_f32 v158, v226, v230
    buffer_store_dwordx3 v[156:158], v10, s[16:19], s39 offen offset:960 sc1
    v_cvt_pk_bf16_f32 v162, v227, v231
    buffer_store_dwordx3 v[160:162], v8, s[16:19], s40 offen offset:384 sc1
    ds_read_b128 v[128:131], v5 offset:6272
    ds_read_b128 v[232:235], v6 offset:0
    ds_read_b128 v[236:239], v6 offset:1024
    ds_read_b128 v[240:243], v6 offset:2048
    s_cbranch_vccnz L_slow
L_cont:
    s_mov_b32 s25, 0
    s_mov_b32 s31, s32
    s_mov_b32 s32, s33
    s_lshl_b64 s[42:43], s[42:43], 16
    s_lshl_b64 s[26:27], s[26:27], 4
    s_add_u32 s29, s29, 1
    s_sub_u32 s21, s21, 1
    s_cmp_eq_u32 s21, 2
    s_cselect_b32 s25, 3, 0
    s_and_b32 s48, s47, 3
    s_lshr_b32 s47, s47, 2
    s_setprio 0
    s_cmp_eq_u32 s48, 0
    s_cbranch_scc1 L_npc
    s_setprio 1
    s_cmp_eq_u32 s48, 1
    s_cbranch_scc1 L_npc
    s_setprio 2
    s_cmp_eq_u32 s48, 2
    s_cbranch_scc1 L_npc
    s_setprio 3
L_npc:
    s_cmp_lg_u32 s21, 0
    s_cbranch_scc1 L_loop

L_end:
    s_endpgm
L_oh1:
    s_nop 7
    v_mov_b32 v132, s22
L_ph:
    ds_read_b32 v133, v132 offset:37232
    s_waitcnt lgkmcnt(0)
    v_readfirstlane_b32 s48, v133
    s_nop 0
    s_cmp_lt_u32 s48, 1
    s_cbranch_scc1 L_ph
    s_nop 1
    s_branch L_rh1
L_on:
    s_nop 7
    v_mov_b32 v1, 0
L_pn2:
    ds_read_b32 v22, v1 offset:37228
    s_waitcnt lgkmcnt(0)
    v_readfirstlane_b32 s48, v22
    s_nop 0
    s_cmp_lt_u32 s48, 4
    s_cbranch_scc1 L_pn2
    s_mov_b32 exec_hi, 0xffff
    ds_read_u16 v54, v23 offset:46080
    ds_read_u16 v62, v23 offset:46082
    ds_read_u16 v70, v23 offset:46084
    ds_read_u16 v78, v23 offset:46086
    ds_read_u16 v86, v23 offset:46088
    ds_read_u16 v94, v23 offset:46090
    s_mov_b64 exec, -1
    s_waitcnt lgkmcnt(0)
    s_nop 1
    s_branch L_rn
L_oh2:
    s_nop 7
    v_mov_b32 v21, s22
    v_mov_b32 v23, 1
    s_mov_b64 exec, 1
    ds_add_u32 v21, v23 offset:37232
    s_mov_b64 exec, -1
    s_nop 1
    s_branch L_rh2
L_oa:
    s_nop 7
    v_mov_b32 v1, s22
    v_mov_b32 v22, 1
    s_mov_b64 exec, 1
    ds_add_u32 v1, v22 offset:37232
    s_mov_b64 exec, -1
    s_mov_b32 m0, s44
    s_nop 0
    buffer_load_dwordx4 v12, s[12:15], s32 offen nt lds
    buffer_load_dwordx4 v13, s[12:15], s32 offen offset:1024 nt lds
    buffer_load_dwordx4 v14, s[12:15], s32 offen offset:2048 nt lds
    buffer_load_dwordx4 v15, s[12:15], s32 offen offset:3072 nt lds
    s_mov_b32 m0, s45
    s_nop 0
    buffer_load_dwordx4 v16, s[12:15], s32 offen nt lds
    buffer_load_dwordx4 v17, s[12:15], s32 offen offset:1024 nt lds
    buffer_load_dwordx4 v18, s[12:15], s32 offen offset:2048 nt lds
    buffer_load_dwordx4 v19, s[12:15], s32 offen offset:3072 nt lds
    s_mov_b32 m0, s46
    s_nop 0
    buffer_load_dwordx4 v20, s[12:15], s32 offen nt lds
    s_nop 1
    s_branch L_ra
L_prepN:
    v_mul_u32_u24 v4, 192, v4
    v_lshl_add_u32 v4, v7, 4, v4
    v_add_u32 v160, 124416, v4
    v_lshl_add_u32 v162, v2, 3, v3
    v_mul_u32_u24 v162, 192, v162
    v_lshl_add_u32 v162, v21, 3, v162
    s_lshl_b32 s53, s48, 5
    s_add_u32 s54, s53, 142848
    v_add_u32 v162, s54, v162
    s_add_u32 s54, s53, 46080
    v_lshl_add_u32 v166, v2, 3, v166
    v_add_u32 v166, s54, v166
    s_lshl_b32 s53, s48, 4
    v_lshlrev_b32 v161, 8, v2
    v_add_u32 v161, 18432, v161
    s_movk_i32 s54, 3120
    v_add_u32 v7, s53, v1
    v_mul_u32_u24 v163, 43, v7
    v_lshrrev_b32 v163, 8, v163
    v_mul_u32_u24 v4, 6, v163
    v_sub_u32 v7, v7, v4
    v_lshl_add_u32 v163, v163, 4, v161
    v_mad_u32_u24 v164, v7, s54, v163
    v_add_u32 v7, s53, v1
    v_add_u32 v7, 32, v7
    v_mul_u32_u24 v163, 43, v7
    v_lshrrev_b32 v163, 8, v163
    v_mul_u32_u24 v4, 6, v163
    v_sub_u32 v7, v7, v4
    v_lshl_add_u32 v163, v163, 4, v161
    v_mad_u32_u24 v165, v7, s54, v163
    s_cmp_lt_u32 s48, 2
    s_cselect_b64 vcc, -1, 0
    v_add_u32 v4, 0, v0
    v_mul_u32_u24 v7, 0x1556, v4
    v_lshrrev_b32 v7, 16, v7
    v_mul_u32_u24 v7, 384, v7
    v_add_u32 v7, 384, v7
    v_add_u32 v7, v7, v6
    v_cndmask_b32 v240, v6, v7, vcc
    v_add_u32 v4, 64, v0
    v_mul_u32_u24 v7, 0x1556, v4
    v_lshrrev_b32 v7, 16, v7
    v_mul_u32_u24 v7, 384, v7
    v_add_u32 v7, 384, v7
    v_add_u32 v7, v7, v6
    v_cndmask_b32 v241, v6, v7, vcc
    v_add_u32 v4, 128, v0
    v_mul_u32_u24 v7, 0x1556, v4
    v_lshrrev_b32 v7, 16, v7
    v_mul_u32_u24 v7, 384, v7
    v_add_u32 v7, 384, v7
    v_add_u32 v7, v7, v6
    v_cndmask_b32 v242, v6, v7, vcc
    s_movk_i32 s58, 3072
    s_cselect_b32 s58, 9216, s58
    s_cselect_b32 s60, 32, 0
    s_mov_b32 s70, 55296
    s_cselect_b32 s70, s70, 18432
    s_mov_b32 s71, 0x20000
    s_cselect_b64 s[68:69], s[6:7], s[8:9]
    s_and_b32 s56, s48, 1
    s_mul_i32 s56, s56, 3
    s_mul_i32 s51, s56, s58
    s_mul_i32 s50, s48, 9216
    s_add_u32 s50, s50, 124416
    s_waitcnt vmcnt(0)
    v_mov_b32 v4, 0
    v_mov_b32 v7, 1
    s_mov_b64 exec, 1
    ds_add_u32 v4, v7 offset:37216
    s_mov_b64 exec, -1
    s_setprio 0
    v_mov_b32 v24, 0
    v_mov_b32 v25, 0
    v_mov_b32 v26, 0
    v_mov_b32 v27, 0
    v_mov_b32 v28, 0
    v_mov_b32 v29, 0
    v_mov_b32 v30, 0
    v_mov_b32 v31, 0
    v_mov_b32 v32, 0
    v_mov_b32 v33, 0
    v_mov_b32 v34, 0
    v_mov_b32 v35, 0
    v_mov_b32 v36, 0
    v_mov_b32 v37, 0
    v_mov_b32 v38, 0
    v_mov_b32 v39, 0
    v_mov_b32 v40, 0
    v_mov_b32 v41, 0
    v_mov_b32 v42, 0
    v_mov_b32 v43, 0
    v_mov_b32 v44, 0
    v_mov_b32 v45, 0
    v_mov_b32 v46, 0
    v_mov_b32 v47, 0
    s_sub_u32 s61, s28, 4
    s_mul_i32 s62, s61, 3072
    s_sub_u32 s63, s64, s44
    v_add_u32 v2, s63, v5
    v_add_u32 v1, s62, v2
    v_and_b32 v195, 48, v0
    v_add_u32 v195, 41216, v195
    s_cmp_eq_u32 s61, 3
    s_cselect_b64 vcc, -1, 0
    v_cndmask_b32 v1, v1, v195, vcc
    v_bfe_u32 v177, v0, 2, 2
    v_lshrrev_b32 v176, 4, v0
    v_lshl_add_u32 v3, v177, 2, v176
    v_mul_u32_u24 v3, 192, v3
    v_and_b32 v21, 3, v0
    v_xor_b32 v177, v177, v21
    v_lshl_add_u32 v3, v177, 4, v3
    v_add_u32 v3, s64, v3
    v_lshlrev_b32 v21, 4, v21
    s_lshl_b32 s62, s61, 4
    s_mov_b32 s63, 96768
    v_add_u32 v176, s62, v176
    v_and_b32 v179, 15, v0
    v_mul_u32_u24 v179, 12, v179
    v_mov_b32 v192, 0x40000000
    v_add_u32 v177, 0, v176
    v_mul_u32_u24 v178, 37, v177
    v_lshrrev_b32 v178, 8, v178
    v_mad_u32_u24 v188, v178, s63, v179
    v_mul_u32_u24 v178, 192, v177
    v_add_u32 v188, v188, v178
    v_cmp_gt_u32 vcc, 49, v177
    s_nop 1
    v_cndmask_b32 v188, v192, v188, vcc
    v_add_u32 v177, 4, v176
    v_mul_u32_u24 v178, 37, v177
    v_lshrrev_b32 v178, 8, v178
    v_mad_u32_u24 v189, v178, s63, v179
    v_mul_u32_u24 v178, 192, v177
    v_add_u32 v189, v189, v178
    v_cmp_gt_u32 vcc, 49, v177
    s_nop 1
    v_cndmask_b32 v189, v192, v189, vcc
    v_add_u32 v177, 8, v176
    v_mul_u32_u24 v178, 37, v177
    v_lshrrev_b32 v178, 8, v178
    v_mad_u32_u24 v190, v178, s63, v179
    v_mul_u32_u24 v178, 192, v177
    v_add_u32 v190, v190, v178
    v_cmp_gt_u32 vcc, 49, v177
    s_nop 1
    v_cndmask_b32 v190, v192, v190, vcc
    v_add_u32 v177, 12, v176
    v_mul_u32_u24 v178, 37, v177
    v_lshrrev_b32 v178, 8, v178
    v_mad_u32_u24 v191, v178, s63, v179
    v_mul_u32_u24 v178, 192, v177
    v_add_u32 v191, v191, v178
    v_cmp_gt_u32 vcc, 49, v177
    s_nop 1
    v_cndmask_b32 v191, v192, v191, vcc
    s_setprio 0
    s_mov_b32 m0, s50
    s_lshl_b32 s52, s56, 5
    s_and_b32 s52, s52, s60
    v_xor_b32 v244, s52, v240
    buffer_load_dwordx4 v244, s[68:71], s51 offen lds
    v_xor_b32 v245, s52, v241
    buffer_load_dwordx4 v245, s[68:71], s51 offen offset:1024 lds
    v_xor_b32 v246, s52, v242
    buffer_load_dwordx4 v246, s[68:71], s51 offen offset:2048 lds
    s_add_u32 s56, s56, 1
    s_add_u32 s51, s51, s58
    s_add_u32 s50, s50, 3072
    s_mov_b32 m0, s50
    s_lshl_b32 s52, s56, 5
    s_and_b32 s52, s52, s60
    v_xor_b32 v244, s52, v240
    buffer_load_dwordx4 v244, s[68:71], s51 offen lds
    v_xor_b32 v245, s52, v241
    buffer_load_dwordx4 v245, s[68:71], s51 offen offset:1024 lds
    v_xor_b32 v246, s52, v242
    buffer_load_dwordx4 v246, s[68:71], s51 offen offset:2048 lds
    s_add_u32 s56, s56, 1
    s_add_u32 s51, s51, s58
    s_add_u32 s50, s50, 3072
    s_mov_b32 m0, s50
    s_lshl_b32 s52, s56, 5
    s_and_b32 s52, s52, s60
    v_xor_b32 v244, s52, v240
    buffer_load_dwordx4 v244, s[68:71], s51 offen lds
    v_xor_b32 v245, s52, v241
    buffer_load_dwordx4 v245, s[68:71], s51 offen offset:1024 lds
    v_xor_b32 v246, s52, v242
    buffer_load_dwordx4 v246, s[68:71], s51 offen offset:2048 lds
    s_waitcnt vmcnt(0)
    v_mov_b32 v4, 0
    v_mov_b32 v7, 1
    s_mov_b64 exec, 1
    ds_add_u32 v4, v7 offset:37224
    s_mov_b64 exec, -1
    s_setprio 0
    v_mov_b32 v4, 0
L_pb:
    ds_read_b32 v7, v4 offset:37224
    s_waitcnt lgkmcnt(0)
    v_readfirstlane_b32 s53, v7
    s_nop 0
    s_cmp_lt_u32 s53, 4
    s_cbranch_scc1 L_pb
    ds_read_b64_tr_b16 v[120:121], v162 offset:0
    ds_read_b64_tr_b16 v[122:123], v162 offset:768
    ds_read_b64_tr_b16 v[124:125], v162 offset:6144
    ds_read_b64_tr_b16 v[126:127], v162 offset:6912
    ds_read_b64_tr_b16 v[128:129], v162 offset:12288
    ds_read_b64_tr_b16 v[130:131], v162 offset:13056
    ds_read_b128 v[48:51], v160 offset:0
    ds_read_b128 v[52:55], v160 offset:64
    ds_read_b128 v[56:59], v160 offset:128
    ds_read_b128 v[60:63], v160 offset:768
    ds_read_b128 v[64:67], v160 offset:832
    ds_read_b128 v[68:71], v160 offset:896
    ds_read_b128 v[72:75], v160 offset:6144
    ds_read_b128 v[76:79], v160 offset:6208
    ds_read_b128 v[80:83], v160 offset:6272
    s_waitcnt lgkmcnt(14)
    ds_read_b128 v[84:87], v160 offset:6912
    s_waitcnt lgkmcnt(14)
    ds_read_b128 v[88:91], v160 offset:6976
    s_waitcnt lgkmcnt(10)
    v_mfma_f32_16x16x32_bf16 v[144:147], v[48:51], v[120:123], 0
    ds_read_b128 v[92:95], v160 offset:7040
    ds_read_b128 v[96:99], v160 offset:12288
    s_waitcnt lgkmcnt(11)
    v_mfma_f32_16x16x32_bf16 v[144:147], v[52:55], v[124:127], v[144:147]
    ds_read_b128 v[100:103], v160 offset:12352
    ds_read_b128 v[104:107], v160 offset:12416
    s_waitcnt lgkmcnt(12)
    v_mfma_f32_16x16x32_bf16 v[144:147], v[56:59], v[128:131], v[144:147]
    ds_read_b128 v[108:111], v160 offset:13056
    ds_read_b128 v[112:115], v160 offset:13120
    s_waitcnt lgkmcnt(13)
    v_mfma_f32_16x16x32_bf16 v[148:151], v[60:63], v[120:123], 0
    ds_read_b128 v[116:119], v160 offset:13184
    ds_read_b128 v[204:207], v167 offset:37376
    s_waitcnt lgkmcnt(14)
    v_mfma_f32_16x16x32_bf16 v[148:151], v[64:67], v[124:127], v[148:151]
    ds_read_b128 v[208:211], v167 offset:37440
    s_waitcnt lgkmcnt(14)
    ds_read_b128 v[212:215], v167 offset:37504
    v_mfma_f32_16x16x32_bf16 v[148:151], v[68:71], v[128:131], v[148:151]
    s_waitcnt lgkmcnt(14)
    ds_read_b128 v[216:219], v167 offset:40448
    s_waitcnt lgkmcnt(14)
    ds_read_b128 v[220:223], v167 offset:40512
    v_mfma_f32_16x16x32_bf16 v[152:155], v[72:75], v[120:123], 0
    s_waitcnt lgkmcnt(14)
    ds_read_b128 v[224:227], v167 offset:40576
    s_waitcnt lgkmcnt(14)
    ds_read_b64_tr_b16 v[240:241], v162 offset:64
    v_mfma_f32_16x16x32_bf16 v[152:155], v[76:79], v[124:127], v[152:155]
    s_waitcnt lgkmcnt(14)
    ds_read_b64_tr_b16 v[242:243], v162 offset:832
    s_waitcnt lgkmcnt(14)
    ds_read_b64_tr_b16 v[244:245], v162 offset:6208
    v_mfma_f32_16x16x32_bf16 v[152:155], v[80:83], v[128:131], v[152:155]
    s_waitcnt lgkmcnt(14)
    ds_read_b64_tr_b16 v[246:247], v162 offset:6976
    s_waitcnt lgkmcnt(14)
    ds_read_b64_tr_b16 v[248:249], v162 offset:12352
    v_mfma_f32_16x16x32_bf16 v[156:159], v[84:87], v[120:123], 0
    s_waitcnt lgkmcnt(14)
    ds_read_b64_tr_b16 v[250:251], v162 offset:13120
    v_cvt_pk_bf16_f32 v132, v144, v145
    v_mfma_f32_16x16x32_bf16 v[156:159], v[88:91], v[124:127], v[156:159]
    v_cvt_pk_bf16_f32 v133, v146, v147
    v_cvt_pk_bf16_f32 v134, v148, v149
    v_mfma_f32_16x16x32_bf16 v[156:159], v[92:95], v[128:131], v[156:159]
    v_cvt_pk_bf16_f32 v135, v150, v151
    s_waitcnt lgkmcnt(14)
    ds_write_b128 v164, v[132:135] offset:0
    v_mfma_f32_16x16x32_bf16 v[144:147], v[96:99], v[120:123], 0
    v_cvt_pk_bf16_f32 v136, v152, v153
    v_cvt_pk_bf16_f32 v137, v154, v155
    v_mfma_f32_16x16x32_bf16 v[144:147], v[100:103], v[124:127], v[144:147]
    v_mfma_f32_16x16x32_bf16 v[144:147], v[104:107], v[128:131], v[144:147]
    v_cvt_pk_bf16_f32 v138, v156, v157
    v_mfma_f32_16x16x32_bf16 v[148:151], v[108:111], v[120:123], 0
    v_cvt_pk_bf16_f32 v139, v158, v159
    s_waitcnt lgkmcnt(14)
    ds_write_b128 v164, v[136:139] offset:1024
    v_mfma_f32_16x16x32_bf16 v[148:151], v[112:115], v[124:127], v[148:151]
    s_waitcnt lgkmcnt(14)
    v_mfma_f32_16x16x32_bf16 v[148:151], v[116:119], v[128:131], v[148:151]
    v_cvt_pk_bf16_f32 v140, v144, v145
    s_waitcnt lgkmcnt(13)
    v_mfma_f32_16x16x32_bf16 v[152:155], v[132:135], v[204:207], 0
    v_cvt_pk_bf16_f32 v141, v146, v147
    s_waitcnt lgkmcnt(12)
    v_mfma_f32_16x16x32_bf16 v[152:155], v[136:139], v[208:211], v[152:155]
    s_nop 1
    v_cvt_pk_bf16_f32 v142, v148, v149
    v_cvt_pk_bf16_f32 v143, v150, v151
    ds_write_b128 v164, v[140:143] offset:2048
    s_waitcnt lgkmcnt(12)
    v_mfma_f32_16x16x32_bf16 v[152:155], v[140:143], v[212:215], v[152:155]
    s_waitcnt lgkmcnt(11)
    v_mfma_f32_16x16x32_bf16 v[156:159], v[132:135], v[216:219], 0
    s_waitcnt lgkmcnt(10)
    v_mfma_f32_16x16x32_bf16 v[156:159], v[136:139], v[220:223], v[156:159]
    s_waitcnt lgkmcnt(9)
    v_mfma_f32_16x16x32_bf16 v[156:159], v[140:143], v[224:227], v[156:159]
    s_nop 1
    v_cvt_pk_bf16_f32 v152, v152, v153
    v_cvt_pk_bf16_f32 v153, v154, v155
    ds_write_b64 v166, v[152:153] offset:0
    s_nop 2
    v_cvt_pk_bf16_f32 v156, v156, v157
    v_cvt_pk_bf16_f32 v157, v158, v159
    s_mov_b32 exec_lo, 0x00ff00ff
    s_mov_b32 exec_hi, 0x00ff00ff
    ds_write_b64 v166, v[156:157] offset:3072
    s_mov_b64 exec, -1
    s_waitcnt lgkmcnt(0)
    s_bitcmp0_b32 s28, 1
    s_cbranch_scc1 L_pp1
    v_mfma_f32_16x16x32_bf16 v[144:147], v[48:51], v[240:243], 0
    v_mfma_f32_16x16x32_bf16 v[144:147], v[52:55], v[244:247], v[144:147]
    v_mfma_f32_16x16x32_bf16 v[144:147], v[56:59], v[248:251], v[144:147]
    v_mfma_f32_16x16x32_bf16 v[148:151], v[60:63], v[240:243], 0
    v_mfma_f32_16x16x32_bf16 v[148:151], v[64:67], v[244:247], v[148:151]
    v_mfma_f32_16x16x32_bf16 v[148:151], v[68:71], v[248:251], v[148:151]
    v_mfma_f32_16x16x32_bf16 v[152:155], v[72:75], v[240:243], 0
    v_mfma_f32_16x16x32_bf16 v[152:155], v[76:79], v[244:247], v[152:155]
    v_mfma_f32_16x16x32_bf16 v[152:155], v[80:83], v[248:251], v[152:155]
    v_mfma_f32_16x16x32_bf16 v[156:159], v[84:87], v[240:243], 0
    s_nop 0
    v_cvt_pk_bf16_f32 v132, v144, v145
    v_mfma_f32_16x16x32_bf16 v[156:159], v[88:91], v[244:247], v[156:159]
    v_cvt_pk_bf16_f32 v133, v146, v147
    v_cvt_pk_bf16_f32 v134, v148, v149
    v_mfma_f32_16x16x32_bf16 v[156:159], v[92:95], v[248:251], v[156:159]
    v_cvt_pk_bf16_f32 v135, v150, v151
    ds_write_b128 v165, v[132:135] offset:0
    v_mfma_f32_16x16x32_bf16 v[144:147], v[96:99], v[240:243], 0
    v_cvt_pk_bf16_f32 v136, v152, v153
    v_cvt_pk_bf16_f32 v137, v154, v155
    v_mfma_f32_16x16x32_bf16 v[144:147], v[100:103], v[244:247], v[144:147]
    v_mfma_f32_16x16x32_bf16 v[144:147], v[104:107], v[248:251], v[144:147]
    s_nop 0
    v_cvt_pk_bf16_f32 v138, v156, v157
    v_mfma_f32_16x16x32_bf16 v[148:151], v[108:111], v[240:243], 0
    v_cvt_pk_bf16_f32 v139, v158, v159
    ds_write_b128 v165, v[136:139] offset:1024
    v_mfma_f32_16x16x32_bf16 v[148:151], v[112:115], v[244:247], v[148:151]
    v_mfma_f32_16x16x32_bf16 v[148:151], v[116:119], v[248:251], v[148:151]
    s_nop 0
    v_cvt_pk_bf16_f32 v140, v144, v145
    v_mfma_f32_16x16x32_bf16 v[152:155], v[132:135], v[204:207], 0
    v_cvt_pk_bf16_f32 v141, v146, v147
    v_mfma_f32_16x16x32_bf16 v[152:155], v[136:139], v[208:211], v[152:155]
    s_nop 2
    v_cvt_pk_bf16_f32 v142, v148, v149
    v_cvt_pk_bf16_f32 v143, v150, v151
    ds_write_b128 v165, v[140:143] offset:2048
    s_nop 0
    v_mfma_f32_16x16x32_bf16 v[152:155], v[140:143], v[212:215], v[152:155]
    v_mfma_f32_16x16x32_bf16 v[156:159], v[132:135], v[216:219], 0
    v_mfma_f32_16x16x32_bf16 v[156:159], v[136:139], v[220:223], v[156:159]
    v_mfma_f32_16x16x32_bf16 v[156:159], v[140:143], v[224:227], v[156:159]
    s_nop 4
    v_cvt_pk_bf16_f32 v152, v152, v153
    v_cvt_pk_bf16_f32 v153, v154, v155
    ds_write_b64 v166, v[152:153] offset:64
    v_cvt_pk_bf16_f32 v156, v156, v157
    v_cvt_pk_bf16_f32 v157, v158, v159
    s_mov_b32 exec_lo, 0x00ff00ff
    s_mov_b32 exec_hi, 0x00ff00ff
    ds_write_b64 v166, v[156:157] offset:3136
    s_mov_b64 exec, -1
    s_waitcnt lgkmcnt(0)
L_pp1:
    v_mov_b32 v4, 0
    v_mov_b32 v7, 1
    s_mov_b64 exec, 1
    ds_add_u32 v4, v7 offset:37228
    s_mov_b64 exec, -1
    s_cmp_lg_u32 s28, 4
    s_cbranch_scc1 L_q1
    buffer_load_dwordx4 v[204:207], v12, s[12:15], s33 offen
    buffer_load_dwordx4 v[208:211], v13, s[12:15], s33 offen offset:1024
    buffer_load_dwordx4 v[212:215], v14, s[12:15], s33 offen offset:2048
    buffer_load_dwordx4 v[216:219], v15, s[12:15], s33 offen offset:3072
    buffer_load_dwordx4 v[220:223], v16, s[12:15], s33 offen
    buffer_load_dwordx4 v[224:227], v17, s[12:15], s33 offen offset:1024
    buffer_load_dwordx4 v[228:231], v18, s[12:15], s33 offen offset:2048
    buffer_load_dwordx4 v[232:235], v19, s[12:15], s33 offen offset:3072
    buffer_load_dwordx4 v[236:239], v20, s[12:15], s33 offen
L_q1:
    v_mov_b32 v4, 0
L_pm2:
    ds_read_b32 v7, v4 offset:37220
    s_waitcnt lgkmcnt(0)
    v_readfirstlane_b32 s53, v7
    s_nop 0
    s_cmp_lt_u32 s53, 4
    s_cbranch_scc1 L_pm2
    s_mov_b32 m0, s44
    s_nop 0
    buffer_load_dwordx4 v12, s[12:15], s31 offen nt lds
    buffer_load_dwordx4 v13, s[12:15], s31 offen offset:1024 nt lds
    buffer_load_dwordx4 v14, s[12:15], s31 offen offset:2048 nt lds
    buffer_load_dwordx4 v15, s[12:15], s31 offen offset:3072 nt lds
    s_mov_b32 m0, s45
    s_nop 0
    buffer_load_dwordx4 v16, s[12:15], s31 offen nt lds
    buffer_load_dwordx4 v17, s[12:15], s31 offen offset:1024 nt lds
    buffer_load_dwordx4 v18, s[12:15], s31 offen offset:2048 nt lds
    buffer_load_dwordx4 v19, s[12:15], s31 offen offset:3072 nt lds
    s_mov_b32 m0, s46
    s_nop 0
    buffer_load_dwordx4 v20, s[12:15], s31 offen nt lds
    v_mov_b32 v4, 0
L_pn:
    ds_read_b32 v7, v4 offset:37228
    s_waitcnt lgkmcnt(0)
    v_readfirstlane_b32 s53, v7
    s_nop 0
    s_cmp_lt_u32 s53, 4
    s_cbranch_scc1 L_pn
    s_cmp_lg_u32 s28, 4
    s_cbranch_scc1 L_q2
    v_add_u32 v4, 124416, v6
    s_waitcnt vmcnt(9)
    ds_write_b128 v4, v[204:207] offset:0
    ds_write_b128 v4, v[208:211] offset:1024
    ds_write_b128 v4, v[212:215] offset:2048
    ds_write_b128 v4, v[216:219] offset:3072
    ds_write_b128 v4, v[220:223] offset:4096
    ds_write_b128 v4, v[224:227] offset:5120
    ds_write_b128 v4, v[228:231] offset:6144
    ds_write_b128 v4, v[232:235] offset:7168
    ds_write_b128 v4, v[236:239] offset:8192
    s_waitcnt lgkmcnt(0)
    v_mov_b32 v4, 0
    v_mov_b32 v7, 1
    s_mov_b64 exec, 1
    ds_add_u32 v4, v7 offset:37248
    s_mov_b64 exec, -1
L_q2:
    s_and_b32 s48, s47, 3
    s_lshr_b32 s47, s47, 2
    s_setprio 0
    s_cmp_eq_u32 s48, 0
    s_cbranch_scc1 L_npq
    s_setprio 1
    s_cmp_eq_u32 s48, 1
    s_cbranch_scc1 L_npq
    s_setprio 2
    s_cmp_eq_u32 s48, 2
    s_cbranch_scc1 L_npq
    s_setprio 3
L_npq:
    s_cmp_ge_u32 s2, 209
    s_cbranch_scc1 L_nq
    v_mov_b32 v4, 0xff800000
    s_mov_b64 exec, s[42:43]
    v_mov_b32 v4, 0
    s_mov_b64 exec, -1
    v_mov_b32 v193, 0
L_pq:
    ds_read_b32 v194, v193 offset:37248
    s_waitcnt lgkmcnt(0)
    v_readfirstlane_b32 s53, v194
    s_nop 0
    s_cmp_lt_u32 s53, 1
    s_cbranch_scc1 L_pq
    v_mov_b32 v193, s22
L_pqw:
    ds_read_b32 v194, v193 offset:37232
    s_waitcnt lgkmcnt(0)
    v_readfirstlane_b32 s53, v194
    s_nop 0
    s_cmp_lt_u32 s53, 2
    s_cbranch_scc1 L_pqw
    ds_read_b128 v[164:167], v1 offset:0
    ds_read_b128 v[168:171], v1 offset:64
    ds_read_b128 v[172:175], v1 offset:128
    ds_read_b128 v[232:235], v6 offset:0
    ds_read_b128 v[236:239], v6 offset:1024
    ds_read_b128 v[240:243], v6 offset:2048
    ds_read_b128 v[244:247], v6 offset:3072
    ds_read_b128 v[248:251], v6 offset:4096
    ds_read_b128 v[252:255], v6 offset:5120
    ds_read_b128 v[180:183], v6 offset:6144
    ds_read_b128 v[184:187], v6 offset:7168
    s_waitcnt lgkmcnt(7)
    v_mfma_f32_16x16x32_bf16 v[208:211], v[232:235], v[164:167], 0
    ds_read_b128 v[232:235], v6 offset:8192
    s_waitcnt lgkmcnt(7)
    v_mfma_f32_16x16x32_bf16 v[208:211], v[236:239], v[168:171], v[208:211]
    ds_read_b128 v[236:239], v6 offset:9216
    s_waitcnt lgkmcnt(7)
    v_mfma_f32_16x16x32_bf16 v[208:211], v[240:243], v[172:175], v[208:211]
    ds_read_b128 v[240:243], v6 offset:10240
    s_waitcnt lgkmcnt(7)
    v_mfma_f32_16x16x32_bf16 v[212:215], v[244:247], v[164:167], 0
    ds_read_b128 v[244:247], v6 offset:11264
    s_waitcnt lgkmcnt(7)
    v_mfma_f32_16x16x32_bf16 v[212:215], v[248:251], v[168:171], v[212:215]
    ds_read_b128 v[248:251], v6 offset:12288
    s_waitcnt lgkmcnt(7)
    v_mfma_f32_16x16x32_bf16 v[212:215], v[252:255], v[172:175], v[212:215]
    ds_read_b128 v[252:255], v6 offset:13312
    s_waitcnt lgkmcnt(7)
    v_mfma_f32_16x16x32_bf16 v[216:219], v[180:183], v[164:167], 0
    ds_read_b128 v[180:183], v6 offset:14336
    v_cvt_pk_bf16_f32 v148, v208, v209
    s_waitcnt lgkmcnt(7)
    v_mfma_f32_16x16x32_bf16 v[216:219], v[184:187], v[168:171], v[216:219]
    ds_read_b128 v[184:187], v6 offset:15360
    v_cvt_pk_bf16_f32 v149, v210, v211
    v_cvt_pk_bf16_f32 v150, v212, v213
    v_cvt_pk_bf16_f32 v151, v214, v215
    s_waitcnt lgkmcnt(7)
    v_mfma_f32_16x16x32_bf16 v[216:219], v[232:235], v[172:175], v[216:219]
    ds_read_b128 v[232:235], v6 offset:16384
    s_waitcnt lgkmcnt(7)
    v_mfma_f32_16x16x32_bf16 v[220:223], v[236:239], v[164:167], 0
    ds_read_b128 v[236:239], v6 offset:17408
    ds_read_b128 v[96:99], v2 offset:0
    s_waitcnt lgkmcnt(8)
    v_mfma_f32_16x16x32_bf16 v[220:223], v[240:243], v[168:171], v[220:223]
    ds_read_b128 v[108:111], v2 offset:3072
    ds_read_b128 v[120:123], v2 offset:6144
    s_waitcnt lgkmcnt(9)
    v_mfma_f32_16x16x32_bf16 v[220:223], v[244:247], v[172:175], v[220:223]
    ds_read_b128 v[196:199], v195 offset:0
    ds_read_b128 v[100:103], v2 offset:64
    s_waitcnt lgkmcnt(10)
    v_mfma_f32_16x16x32_bf16 v[224:227], v[248:251], v[164:167], 0
    ds_read_b128 v[112:115], v2 offset:3136
    ds_read_b128 v[124:127], v2 offset:6208
    s_waitcnt lgkmcnt(11)
    v_mfma_f32_16x16x32_bf16 v[224:227], v[252:255], v[168:171], v[224:227]
    ds_read_b128 v[200:203], v195 offset:64
    ds_read_b128 v[104:107], v2 offset:128
    s_waitcnt lgkmcnt(12)
    v_mfma_f32_16x16x32_bf16 v[224:227], v[180:183], v[172:175], v[224:227]
    ds_read_b128 v[116:119], v2 offset:3200
    ds_read_b128 v[128:131], v2 offset:6272
    s_waitcnt lgkmcnt(13)
    v_mfma_f32_16x16x32_bf16 v[228:231], v[184:187], v[164:167], 0
    ds_read_b128 v[204:207], v195 offset:128
    ds_read_b64_tr_b16 v[48:49], v3 offset:0
    s_waitcnt lgkmcnt(14)
    ds_read_b64_tr_b16 v[50:51], v3 offset:3072
    s_waitcnt lgkmcnt(14)
    ds_read_b64_tr_b16 v[52:53], v3 offset:6144
    s_waitcnt lgkmcnt(14)
    ds_read_b64_tr_b16 v[54:55], v21 offset:41216
    s_waitcnt lgkmcnt(14)
    ds_read_b64_tr_b16 v[56:57], v3 offset:8
    s_waitcnt lgkmcnt(14)
    ds_read_b64_tr_b16 v[58:59], v3 offset:3080
    s_waitcnt lgkmcnt(14)
    ds_read_b64_tr_b16 v[60:61], v3 offset:6152
    s_waitcnt lgkmcnt(14)
    ds_read_b64_tr_b16 v[62:63], v21 offset:41224
    s_waitcnt lgkmcnt(14)
    ds_read_b64_tr_b16 v[64:65], v3 offset:64
    s_waitcnt lgkmcnt(14)
    ds_read_b64_tr_b16 v[66:67], v3 offset:3136
    s_waitcnt lgkmcnt(14)
    ds_read_b64_tr_b16 v[68:69], v3 offset:6208
    s_waitcnt lgkmcnt(14)
    ds_read_b64_tr_b16 v[70:71], v21 offset:41280
    s_waitcnt lgkmcnt(14)
    ds_read_b64_tr_b16 v[72:73], v3 offset:72
    s_waitcnt lgkmcnt(14)
    ds_read_b64_tr_b16 v[74:75], v3 offset:3144
    s_waitcnt lgkmcnt(14)
    ds_read_b64_tr_b16 v[76:77], v3 offset:6216
    s_waitcnt lgkmcnt(14)
    ds_read_b64_tr_b16 v[78:79], v21 offset:41288
    s_waitcnt lgkmcnt(14)
    ds_read_b64_tr_b16 v[80:81], v3 offset:128
    s_waitcnt lgkmcnt(14)
    ds_read_b64_tr_b16 v[82:83], v3 offset:3200
    s_waitcnt lgkmcnt(14)
    ds_read_b64_tr_b16 v[84:85], v3 offset:6272
    s_waitcnt lgkmcnt(14)
    ds_read_b64_tr_b16 v[86:87], v21 offset:41344
    s_waitcnt lgkmcnt(14)
    ds_read_b64_tr_b16 v[88:89], v3 offset:136
    v_mfma_f32_16x16x32_bf16 v[228:231], v[232:235], v[168:171], v[228:231]
    s_waitcnt lgkmcnt(14)
    ds_read_b64_tr_b16 v[90:91], v3 offset:3208
    s_waitcnt lgkmcnt(14)
    ds_read_b64_tr_b16 v[92:93], v3 offset:6280
    v_mfma_f32_16x16x32_bf16 v[228:231], v[236:239], v[172:175], v[228:231]
    s_waitcnt lgkmcnt(14)
    ds_read_b64_tr_b16 v[94:95], v21 offset:41352
    s_waitcnt lgkmcnt(14)
    ds_read_b128 v[240:243], v6 offset:18432
    v_mfma_f32_16x16x32_bf16 v[132:135], v[96:99], v[148:151], 0
    s_waitcnt lgkmcnt(14)
    ds_read_b128 v[244:247], v6 offset:21552
    s_waitcnt lgkmcnt(14)
    ds_read_b128 v[248:251], v6 offset:24672
    v_mfma_f32_16x16x32_bf16 v[136:139], v[108:111], v[148:151], 0
    s_waitcnt lgkmcnt(14)
    ds_read_b128 v[252:255], v6 offset:27792
    s_waitcnt lgkmcnt(14)
    ds_read_b128 v[180:183], v6 offset:30912
    v_mfma_f32_16x16x32_bf16 v[140:143], v[120:123], v[148:151], 0
    s_waitcnt lgkmcnt(14)
    ds_read_b128 v[184:187], v6 offset:34032
    s_waitcnt lgkmcnt(14)
    ds_read_b128 v[232:235], v6 offset:19456
    v_mfma_f32_16x16x32_bf16 v[144:147], v[196:199], v[148:151], v[4:7]
    s_waitcnt lgkmcnt(14)
    ds_read_b128 v[236:239], v6 offset:22576
    v_cvt_pk_bf16_f32 v152, v216, v217
    v_cvt_pk_bf16_f32 v153, v218, v219
    v_cvt_pk_bf16_f32 v154, v220, v221
    v_cvt_pk_bf16_f32 v155, v222, v223
    v_cvt_pk_bf16_f32 v156, v224, v225
    v_cvt_pk_bf16_f32 v157, v226, v227
    v_mfma_f32_16x16x32_bf16 v[132:135], v[100:103], v[152:155], v[132:135]
    v_cvt_pk_bf16_f32 v158, v228, v229
    v_cvt_pk_bf16_f32 v159, v230, v231
    v_mfma_f32_16x16x32_bf16 v[136:139], v[112:115], v[152:155], v[136:139]
    v_mfma_f32_16x16x32_bf16 v[140:143], v[124:127], v[152:155], v[140:143]
    v_mfma_f32_16x16x32_bf16 v[144:147], v[200:203], v[152:155], v[144:147]
    v_mfma_f32_16x16x32_bf16 v[132:135], v[104:107], v[156:159], v[132:135]
    v_mfma_f32_16x16x32_bf16 v[136:139], v[116:119], v[156:159], v[136:139]
    v_mfma_f32_16x16x32_bf16 v[140:143], v[128:131], v[156:159], v[140:143]
    v_mfma_f32_16x16x32_bf16 v[144:147], v[204:207], v[156:159], v[144:147]
    s_nop 7
    v_max3_f32 v145, v132, v133, v134
    v_max3_f32 v145, v145, v135, v136
    v_max3_f32 v145, v145, v137, v138
    v_max3_f32 v145, v145, v139, v140
    v_max3_f32 v145, v145, v141, v142
    v_max3_f32 v145, v145, v143, v144
    v_mov_b32 v146, v145
    s_nop 1
    v_permlane32_swap_b32 v145, v146
    v_max_f32 v145, v145, v146
    v_mov_b32 v146, v145
    s_nop 1
    v_permlane16_swap_b32 v145, v146
    v_max_f32 v145, v145, v146
    v_sub_f32 v132, v132, v145
    v_sub_f32 v133, v133, v145
    v_sub_f32 v134, v134, v145
    v_sub_f32 v135, v135, v145
    v_sub_f32 v136, v136, v145
    v_sub_f32 v137, v137, v145
    v_sub_f32 v138, v138, v145
    v_sub_f32 v139, v139, v145
    v_sub_f32 v140, v140, v145
    v_sub_f32 v141, v141, v145
    v_sub_f32 v142, v142, v145
    v_sub_f32 v143, v143, v145
    v_sub_f32 v144, v144, v145
    v_exp_f32 v132, v132
    v_exp_f32 v133, v133
    v_exp_f32 v134, v134
    v_add_f32 v147, v132, v133
    v_exp_f32 v135, v135
    v_add_f32 v147, v147, v134
    v_exp_f32 v136, v136
    v_add_f32 v147, v147, v135
    v_exp_f32 v137, v137
    v_add_f32 v147, v147, v136
    v_exp_f32 v138, v138
    v_add_f32 v147, v147, v137
    v_exp_f32 v139, v139
    v_add_f32 v147, v147, v138
    v_exp_f32 v140, v140
    v_add_f32 v147, v147, v139
    v_exp_f32 v141, v141
    v_add_f32 v147, v147, v140
    v_exp_f32 v142, v142
    v_add_f32 v147, v147, v141
    v_exp_f32 v143, v143
    v_add_f32 v147, v147, v142
    v_exp_f32 v144, v144
    v_add_f32 v147, v147, v143
    v_add_f32 v147, v147, v144
    v_mov_b32 v146, v147
    s_nop 1
    v_permlane32_swap_b32 v147, v146
    v_add_f32 v147, v147, v146
    v_mov_b32 v146, v147
    s_nop 1
    v_permlane16_swap_b32 v147, v146
    v_add_f32 v147, v147, v146
    v_rcp_f32 v145, v147
    s_nop 0
    v_mul_f32 v132, v132, v145
    v_mul_f32 v133, v133, v145
    v_cvt_pk_bf16_f32 v132, v132, v133
    v_mul_f32 v134, v134, v145
    v_mul_f32 v135, v135, v145
    v_cvt_pk_bf16_f32 v133, v134, v135
    v_mul_f32 v136, v136, v145
    v_mul_f32 v137, v137, v145
    v_cvt_pk_bf16_f32 v134, v136, v137
    v_mul_f32 v138, v138, v145
    v_mul_f32 v139, v139, v145
    v_cvt_pk_bf16_f32 v135, v138, v139
    v_mul_f32 v140, v140, v145
    v_mul_f32 v141, v141, v145
    v_mfma_f32_16x16x32_bf16 v[208:211], v[48:51], v[132:135], 0
    v_cvt_pk_bf16_f32 v136, v140, v141
    v_mul_f32 v142, v142, v145
    v_mul_f32 v143, v143, v145
    v_cvt_pk_bf16_f32 v137, v142, v143
    v_mul_f32 v144, v144, v145
    v_cvt_pk_bf16_f32 v138, v144, 0
    v_mov_b32 v139, 0
    s_nop 1
    v_mfma_f32_16x16x32_bf16 v[208:211], v[52:55], v[136:139], v[208:211]
    v_mfma_f32_16x16x32_bf16 v[212:215], v[56:59], v[132:135], 0
    v_mfma_f32_16x16x32_bf16 v[212:215], v[60:63], v[136:139], v[212:215]
    v_mfma_f32_16x16x32_bf16 v[216:219], v[64:67], v[132:135], 0
    v_mfma_f32_16x16x32_bf16 v[216:219], v[68:71], v[136:139], v[216:219]
    v_mfma_f32_16x16x32_bf16 v[220:223], v[72:75], v[132:135], 0
    v_mfma_f32_16x16x32_bf16 v[220:223], v[76:79], v[136:139], v[220:223]
    s_waitcnt lgkmcnt(14)
    v_mfma_f32_16x16x32_bf16 v[224:227], v[80:83], v[132:135], 0
    v_cvt_pk_bf16_f32 v148, v208, v209
    s_waitcnt lgkmcnt(12)
    v_mfma_f32_16x16x32_bf16 v[224:227], v[84:87], v[136:139], v[224:227]
    v_cvt_pk_bf16_f32 v149, v210, v211
    v_cvt_pk_bf16_f32 v150, v212, v213
    s_waitcnt lgkmcnt(10)
    v_mfma_f32_16x16x32_bf16 v[228:231], v[88:91], v[132:135], 0
    v_cvt_pk_bf16_f32 v151, v214, v215
    v_cvt_pk_bf16_f32 v152, v216, v217
    s_waitcnt lgkmcnt(8)
    v_mfma_f32_16x16x32_bf16 v[228:231], v[92:95], v[136:139], v[228:231]
    v_cvt_pk_bf16_f32 v153, v218, v219
    v_cvt_pk_bf16_f32 v154, v220, v221
    s_waitcnt lgkmcnt(7)
    v_mfma_f32_16x16x32_bf16 v[96:99], v[148:151], v[240:243], 0
    ds_read_b128 v[240:243], v6 offset:25696
    v_cvt_pk_bf16_f32 v155, v222, v223
    s_waitcnt lgkmcnt(7)
    v_mfma_f32_16x16x32_bf16 v[100:103], v[148:151], v[244:247], 0
    ds_read_b128 v[244:247], v6 offset:28816
    v_cvt_pk_bf16_f32 v156, v224, v225
    s_waitcnt lgkmcnt(7)
    v_mfma_f32_16x16x32_bf16 v[104:107], v[148:151], v[248:251], 0
    ds_read_b128 v[248:251], v6 offset:31936
    v_cvt_pk_bf16_f32 v157, v226, v227
    s_waitcnt lgkmcnt(7)
    v_mfma_f32_16x16x32_bf16 v[108:111], v[148:151], v[252:255], 0
    ds_read_b128 v[252:255], v6 offset:35056
    v_cvt_pk_bf16_f32 v158, v228, v229
    s_waitcnt lgkmcnt(7)
    v_mfma_f32_16x16x32_bf16 v[112:115], v[148:151], v[180:183], 0
    ds_read_b128 v[180:183], v6 offset:20480
    v_cvt_pk_bf16_f32 v159, v230, v231
    s_waitcnt lgkmcnt(7)
    v_mfma_f32_16x16x32_bf16 v[116:119], v[148:151], v[184:187], 0
    ds_read_b128 v[184:187], v6 offset:23600
    s_waitcnt lgkmcnt(7)
    v_mfma_f32_16x16x32_bf16 v[96:99], v[152:155], v[232:235], v[96:99]
    ds_read_b128 v[232:235], v6 offset:26720
    s_waitcnt lgkmcnt(7)
    v_mfma_f32_16x16x32_bf16 v[100:103], v[152:155], v[236:239], v[100:103]
    ds_read_b128 v[236:239], v6 offset:29840
    s_waitcnt lgkmcnt(7)
    v_mfma_f32_16x16x32_bf16 v[104:107], v[152:155], v[240:243], v[104:107]
    ds_read_b128 v[240:243], v6 offset:32960
    s_waitcnt lgkmcnt(7)
    v_mfma_f32_16x16x32_bf16 v[108:111], v[152:155], v[244:247], v[108:111]
    ds_read_b128 v[244:247], v6 offset:36080
    s_waitcnt lgkmcnt(7)
    v_mfma_f32_16x16x32_bf16 v[112:115], v[152:155], v[248:251], v[112:115]
    s_waitcnt lgkmcnt(6)
    v_mfma_f32_16x16x32_bf16 v[116:119], v[152:155], v[252:255], v[116:119]
    s_waitcnt lgkmcnt(5)
    v_mfma_f32_16x16x32_bf16 v[96:99], v[156:159], v[180:183], v[96:99]
    s_waitcnt lgkmcnt(4)
    v_mfma_f32_16x16x32_bf16 v[100:103], v[156:159], v[184:187], v[100:103]
    s_waitcnt lgkmcnt(3)
    v_mfma_f32_16x16x32_bf16 v[104:107], v[156:159], v[232:235], v[104:107]
    s_waitcnt lgkmcnt(2)
    v_mfma_f32_16x16x32_bf16 v[108:111], v[156:159], v[236:239], v[108:111]
    s_nop 3
    v_cvt_pk_bf16_f32 v208, v96, v100
    v_cvt_pk_bf16_f32 v212, v97, v101
    s_nop 1
    v_cvt_pk_bf16_f32 v209, v104, v108
    v_cvt_pk_bf16_f32 v213, v105, v109
    v_cvt_pk_bf16_f32 v216, v98, v102
    v_cvt_pk_bf16_f32 v217, v106, v110
    v_cvt_pk_bf16_f32 v220, v99, v103
    v_cvt_pk_bf16_f32 v221, v107, v111
    s_waitcnt lgkmcnt(1)
    v_mfma_f32_16x16x32_bf16 v[112:115], v[156:159], v[240:243], v[112:115]
    s_waitcnt lgkmcnt(0)
    v_mfma_f32_16x16x32_bf16 v[116:119], v[156:159], v[244:247], v[116:119]
    s_nop 7
    v_cvt_pk_bf16_f32 v210, v112, v116
    s_waitcnt vmcnt(0)
    buffer_store_dwordx3 v[208:210], v188, s[16:19], s33 offen sc1
    v_cvt_pk_bf16_f32 v214, v113, v117
    buffer_store_dwordx3 v[212:214], v189, s[16:19], s33 offen sc1
    v_cvt_pk_bf16_f32 v218, v114, v118
    buffer_store_dwordx3 v[216:218], v190, s[16:19], s33 offen sc1
    v_cvt_pk_bf16_f32 v222, v115, v119
    buffer_store_dwordx3 v[220:222], v191, s[16:19], s33 offen sc1
    s_branch L_nq2
L_nq:
    s_waitcnt vmcnt(0)
L_nq2:
    s_nop 1
    v_mov_b32 v54, 0
    v_mov_b32 v55, 0
    v_mov_b32 v62, 0
    v_mov_b32 v63, 0
    v_mov_b32 v70, 0
    v_mov_b32 v71, 0
    v_mov_b32 v78, 0
    v_mov_b32 v79, 0
    v_mov_b32 v86, 0
    v_mov_b32 v87, 0
    v_mov_b32 v94, 0
    v_mov_b32 v95, 0
    s_mov_b32 exec_hi, 0
    ds_read_u16 v54, v23 offset:46080
    ds_read_u16 v62, v23 offset:46082
    ds_read_u16 v70, v23 offset:46084
    ds_read_u16 v78, v23 offset:46086
    ds_read_u16 v86, v23 offset:46088
    ds_read_u16 v94, v23 offset:46090
    s_mov_b64 exec, -1
    s_waitcnt lgkmcnt(0)
    s_and_b32 s48, s47, 3
    s_lshr_b32 s47, s47, 2
    s_setprio 0
    s_cmp_eq_u32 s48, 0
    s_cbranch_scc1 L_npb
    s_setprio 1
    s_cmp_eq_u32 s48, 1
    s_cbranch_scc1 L_npb
    s_setprio 2
    s_cmp_eq_u32 s48, 2
    s_cbranch_scc1 L_npb
    s_setprio 3
L_npb:
    s_branch L_join
L_slow:
    s_waitcnt vmcnt(0) lgkmcnt(0)
    s_nop 7
    ds_read_b128 v[244:247], v6 offset:3072
    ds_read_b128 v[248:251], v6 offset:4096
    ds_read_b128 v[252:255], v6 offset:5120
    s_mov_b32 s14, 50135232
    s_mov_b32 s48, 96768
    v_and_b32 v2, 3, v0
    v_bfe_u32 v3, v0, 2, 2
    v_lshl_add_u32 v2, v2, 2, v3
    v_lshrrev_b32 v3, 4, v0
    v_lshlrev_b32 v3, 4, v3
    v_add_u32 v21, 0, v2
    v_mul_u32_u24 v22, 37, v21
    v_lshrrev_b32 v22, 8, v22
    v_mul_u32_u24 v21, 192, v21
    v_add_u32 v21, v21, v3
    v_mad_u32_u24 v23, v22, s48, v21
    buffer_load_dwordx4 v[96:99], v23, s[12:15], s31 offen
    buffer_load_dwordx4 v[100:103], v23, s[12:15], s31 offen offset:64
    buffer_load_dwordx4 v[104:107], v23, s[12:15], s31 offen offset:128
    v_add_u32 v21, 16, v2
    v_mul_u32_u24 v22, 37, v21
    v_lshrrev_b32 v22, 8, v22
    v_mul_u32_u24 v21, 192, v21
    v_add_u32 v21, v21, v3
    v_mad_u32_u24 v23, v22, s48, v21
    buffer_load_dwordx4 v[108:111], v23, s[12:15], s31 offen
    buffer_load_dwordx4 v[112:115], v23, s[12:15], s31 offen offset:64
    buffer_load_dwordx4 v[116:119], v23, s[12:15], s31 offen offset:128
    v_add_u32 v21, 32, v2
    v_mul_u32_u24 v22, 37, v21
    v_lshrrev_b32 v22, 8, v22
    v_mul_u32_u24 v21, 192, v21
    v_add_u32 v21, v21, v3
    v_mad_u32_u24 v23, v22, s48, v21
    buffer_load_dwordx4 v[120:123], v23, s[12:15], s31 offen
    buffer_load_dwordx4 v[124:127], v23, s[12:15], s31 offen offset:64
    buffer_load_dwordx4 v[128:131], v23, s[12:15], s31 offen offset:128
    s_waitcnt vmcnt(5)
    v_mfma_f32_16x16x32_bf16 v[184:187], v[108:111], v[36:39], 0
    s_waitcnt vmcnt(4)
    v_mfma_f32_16x16x32_bf16 v[184:187], v[112:115], v[40:43], v[184:187]
    s_waitcnt vmcnt(3)
    v_mfma_f32_16x16x32_bf16 v[184:187], v[116:119], v[44:47], v[184:187]
    s_waitcnt vmcnt(2)
    v_mfma_f32_16x16x32_bf16 v[188:191], v[120:123], v[36:39], 0
    s_waitcnt vmcnt(1)
    v_mfma_f32_16x16x32_bf16 v[188:191], v[124:127], v[40:43], v[188:191]
    s_waitcnt vmcnt(0)
    v_mfma_f32_16x16x32_bf16 v[188:191], v[128:131], v[44:47], v[188:191]
    v_mfma_f32_16x16x32_bf16 v[180:183], v[96:99], v[36:39], v[192:195]
    v_mfma_f32_16x16x32_bf16 v[180:183], v[100:103], v[40:43], v[180:183]
    v_mfma_f32_16x16x32_bf16 v[180:183], v[104:107], v[44:47], v[180:183]
    v_mfma_f32_16x16x32_bf16 v[208:211], v[232:235], v[96:99], 0
    v_mfma_f32_16x16x32_bf16 v[208:211], v[236:239], v[100:103], v[208:211]
    v_mfma_f32_16x16x32_bf16 v[208:211], v[240:243], v[104:107], v[208:211]
    v_mfma_f32_16x16x32_bf16 v[212:215], v[232:235], v[108:111], 0
    v_mfma_f32_16x16x32_bf16 v[212:215], v[236:239], v[112:115], v[212:215]
    v_mfma_f32_16x16x32_bf16 v[212:215], v[240:243], v[116:119], v[212:215]
    v_mfma_f32_16x16x32_bf16 v[216:219], v[232:235], v[120:123], 0
    ds_read_b128 v[232:235], v6 offset:6144
    v_cndmask_b32 v180, v180, v184, s[56:57]
    v_mfma_f32_16x16x32_bf16 v[216:219], v[236:239], v[124:127], v[216:219]
    ds_read_b128 v[236:239], v6 offset:7168
    v_cvt_pk_bf16_f32 v48, v208, v209
    v_mfma_f32_16x16x32_bf16 v[216:219], v[240:243], v[128:131], v[216:219]
    ds_read_b128 v[240:243], v6 offset:8192
    v_cvt_pk_bf16_f32 v49, v210, v211
    s_waitcnt lgkmcnt(3)
    v_mfma_f32_16x16x32_bf16 v[220:223], v[244:247], v[96:99], 0
    v_cvt_pk_bf16_f32 v72, v212, v213
    v_cvt_pk_bf16_f32 v73, v214, v215
    v_mfma_f32_16x16x32_bf16 v[220:223], v[248:251], v[100:103], v[220:223]
    v_cndmask_b32 v181, v181, v185, s[56:57]
    v_cndmask_b32 v182, v182, v186, s[56:57]
    v_mfma_f32_16x16x32_bf16 v[220:223], v[252:255], v[104:107], v[220:223]
    v_cvt_pk_bf16_f32 v196, v216, v217
    v_cvt_pk_bf16_f32 v197, v218, v219
    v_mfma_f32_16x16x32_bf16 v[224:227], v[244:247], v[108:111], 0
    v_cndmask_b32 v183, v183, v187, s[56:57]
    v_cndmask_b32 v180, v180, v188, s[58:59]
    v_mfma_f32_16x16x32_bf16 v[224:227], v[248:251], v[112:115], v[224:227]
    v_cndmask_b32 v181, v181, v189, s[58:59]
    v_cndmask_b32 v182, v182, v190, s[58:59]
    v_mfma_f32_16x16x32_bf16 v[224:227], v[252:255], v[116:119], v[224:227]
    v_cvt_pk_bf16_f32 v50, v220, v221
    v_cvt_pk_bf16_f32 v51, v222, v223
    v_mfma_f32_16x16x32_bf16 v[228:231], v[244:247], v[120:123], 0
    ds_read_b128 v[244:247], v6 offset:9216
    v_cndmask_b32 v183, v183, v191, s[58:59]
    v_mfma_f32_16x16x32_bf16 v[228:231], v[248:251], v[124:127], v[228:231]
    ds_read_b128 v[248:251], v6 offset:10240
    v_max3_f32 v22, v180, v181, v182
    v_mfma_f32_16x16x32_bf16 v[228:231], v[252:255], v[128:131], v[228:231]
    ds_read_b128 v[252:255], v6 offset:11264
    v_cvt_pk_bf16_f32 v74, v224, v225
    s_waitcnt lgkmcnt(3)
    v_mfma_f32_16x16x32_bf16 v[208:211], v[232:235], v[96:99], 0
    v_cvt_pk_bf16_f32 v75, v226, v227
    v_max_f32 v22, v22, v183
    v_mfma_f32_16x16x32_bf16 v[208:211], v[236:239], v[100:103], v[208:211]
    s_nop 0
    v_max_f32_dpp v22, v22, v22 quad_perm:[1,0,3,2] row_mask:0xf bank_mask:0xf
    v_mfma_f32_16x16x32_bf16 v[208:211], v[240:243], v[104:107], v[208:211]
    v_cvt_pk_bf16_f32 v198, v228, v229
    v_cvt_pk_bf16_f32 v199, v230, v231
    v_mfma_f32_16x16x32_bf16 v[212:215], v[232:235], v[108:111], 0
    v_max_f32_dpp v22, v22, v22 quad_perm:[2,3,0,1] row_mask:0xf bank_mask:0xf
    v_mov_b32 v23, v22
    v_mfma_f32_16x16x32_bf16 v[212:215], v[236:239], v[112:115], v[212:215]
    s_nop 0
    v_permlane32_swap_b32 v22, v23
    v_mfma_f32_16x16x32_bf16 v[212:215], v[240:243], v[116:119], v[212:215]
    v_cvt_pk_bf16_f32 v56, v208, v209
    v_cvt_pk_bf16_f32 v57, v210, v211
    v_mfma_f32_16x16x32_bf16 v[216:219], v[232:235], v[120:123], 0
    ds_read_b128 v[232:235], v6 offset:12288
    v_max_f32 v22, v22, v23
    v_mfma_f32_16x16x32_bf16 v[216:219], v[236:239], v[124:127], v[216:219]
    ds_read_b128 v[236:239], v6 offset:13312
    v_mov_b32 v23, v22
    v_mfma_f32_16x16x32_bf16 v[216:219], v[240:243], v[128:131], v[216:219]
    ds_read_b128 v[240:243], v6 offset:14336
    v_cvt_pk_bf16_f32 v80, v212, v213
    s_waitcnt lgkmcnt(3)
    v_mfma_f32_16x16x32_bf16 v[220:223], v[244:247], v[96:99], 0
    v_cvt_pk_bf16_f32 v81, v214, v215
    v_permlane16_swap_b32 v22, v23
    v_mfma_f32_16x16x32_bf16 v[220:223], v[248:251], v[100:103], v[220:223]
    v_max_f32 v22, v22, v23
    v_sub_f32 v180, v180, v22
    v_mfma_f32_16x16x32_bf16 v[220:223], v[252:255], v[104:107], v[220:223]
    v_cvt_pk_bf16_f32 v200, v216, v217
    v_cvt_pk_bf16_f32 v201, v218, v219
    v_mfma_f32_16x16x32_bf16 v[224:227], v[244:247], v[108:111], 0
    v_sub_f32 v181, v181, v22
    v_sub_f32 v182, v182, v22
    v_mfma_f32_16x16x32_bf16 v[224:227], v[248:251], v[112:115], v[224:227]
    v_sub_f32 v183, v183, v22
    v_exp_f32 v180, v180
    v_mfma_f32_16x16x32_bf16 v[224:227], v[252:255], v[116:119], v[224:227]
    v_cvt_pk_bf16_f32 v58, v220, v221
    v_cvt_pk_bf16_f32 v59, v222, v223
    v_mfma_f32_16x16x32_bf16 v[228:231], v[244:247], v[120:123], 0
    ds_read_b128 v[244:247], v6 offset:15360
    v_exp_f32 v181, v181
    v_mfma_f32_16x16x32_bf16 v[228:231], v[248:251], v[124:127], v[228:231]
    ds_read_b128 v[248:251], v6 offset:16384
    v_exp_f32 v182, v182
    v_mfma_f32_16x16x32_bf16 v[228:231], v[252:255], v[128:131], v[228:231]
    ds_read_b128 v[252:255], v6 offset:17408
    v_cvt_pk_bf16_f32 v82, v224, v225
    s_waitcnt lgkmcnt(3)
    v_mfma_f32_16x16x32_bf16 v[208:211], v[232:235], v[96:99], 0
    v_cvt_pk_bf16_f32 v83, v226, v227
    v_add_f32 v21, v180, v181
    v_mfma_f32_16x16x32_bf16 v[208:211], v[236:239], v[100:103], v[208:211]
    v_exp_f32 v183, v183
    v_mfma_f32_16x16x32_bf16 v[208:211], v[240:243], v[104:107], v[208:211]
    v_cvt_pk_bf16_f32 v202, v228, v229
    v_cvt_pk_bf16_f32 v203, v230, v231
    v_mfma_f32_16x16x32_bf16 v[212:215], v[232:235], v[108:111], 0
    v_add_f32 v21, v21, v182
    v_add_f32 v21, v21, v183
    v_mfma_f32_16x16x32_bf16 v[212:215], v[236:239], v[112:115], v[212:215]
    s_nop 0
    v_add_f32_dpp v21, v21, v21 quad_perm:[1,0,3,2] row_mask:0xf bank_mask:0xf
    v_mfma_f32_16x16x32_bf16 v[212:215], v[240:243], v[116:119], v[212:215]
    v_cvt_pk_bf16_f32 v64, v208, v209
    v_cvt_pk_bf16_f32 v65, v210, v211
    v_mfma_f32_16x16x32_bf16 v[216:219], v[232:235], v[120:123], 0
    ds_read_b128 v[232:235], v6 offset:18432
    v_add_f32_dpp v21, v21, v21 quad_perm:[2,3,0,1] row_mask:0xf bank_mask:0xf
    v_mfma_f32_16x16x32_bf16 v[216:219], v[236:239], v[124:127], v[216:219]
    ds_read_b128 v[236:239], v6 offset:19456
    v_mov_b32 v2, v21
    v_mfma_f32_16x16x32_bf16 v[216:219], v[240:243], v[128:131], v[216:219]
    ds_read_b128 v[240:243], v6 offset:20480
    v_cvt_pk_bf16_f32 v88, v212, v213
    s_waitcnt lgkmcnt(3)
    v_mfma_f32_16x16x32_bf16 v[220:223], v[244:247], v[96:99], 0
    v_cvt_pk_bf16_f32 v89, v214, v215
    v_permlane32_swap_b32 v21, v2
    v_mfma_f32_16x16x32_bf16 v[220:223], v[248:251], v[100:103], v[220:223]
    v_add_f32 v21, v21, v2
    v_mov_b32 v2, v21
    v_mfma_f32_16x16x32_bf16 v[220:223], v[252:255], v[104:107], v[220:223]
    v_cvt_pk_bf16_f32 v204, v216, v217
    v_cvt_pk_bf16_f32 v205, v218, v219
    v_mfma_f32_16x16x32_bf16 v[224:227], v[244:247], v[108:111], 0
    v_permlane16_swap_b32 v21, v2
    v_add_f32 v21, v21, v2
    v_mfma_f32_16x16x32_bf16 v[224:227], v[248:251], v[112:115], v[224:227]
    v_rcp_f32 v3, v21
    v_mfma_f32_16x16x32_bf16 v[224:227], v[252:255], v[116:119], v[224:227]
    v_cvt_pk_bf16_f32 v66, v220, v221
    v_cvt_pk_bf16_f32 v67, v222, v223
    v_mfma_f32_16x16x32_bf16 v[228:231], v[244:247], v[120:123], 0
    ds_read_b128 v[244:247], v6 offset:21552
    v_cndmask_b32 v3, 0, v3, s[26:27]
    v_mfma_f32_16x16x32_bf16 v[228:231], v[248:251], v[124:127], v[228:231]
    ds_read_b128 v[248:251], v6 offset:22576
    v_mul_f32 v180, v180, v3
    v_mfma_f32_16x16x32_bf16 v[228:231], v[252:255], v[128:131], v[228:231]
    ds_read_b128 v[252:255], v6 offset:23600
    v_cvt_pk_bf16_f32 v90, v224, v225
    v_mfma_f32_16x16x32_bf16 v[132:135], v[96:99], v[48:51], 0
    v_cvt_pk_bf16_f32 v91, v226, v227
    v_mul_f32 v181, v181, v3
    v_mfma_f32_16x16x32_bf16 v[136:139], v[108:111], v[48:51], 0
    v_mul_f32 v182, v182, v3
    v_mul_f32 v183, v183, v3
    v_mfma_f32_16x16x32_bf16 v[140:143], v[120:123], v[48:51], 0
    v_cvt_pk_bf16_f32 v206, v228, v229
    v_cvt_pk_bf16_f32 v207, v230, v231
    v_mfma_f32_16x16x32_bf16 v[144:147], v[24:27], v[48:51], v[4:7]
    v_cvt_pk_bf16_f32 v180, v180, v181
    v_cvt_pk_bf16_f32 v181, v182, v183
    v_mfma_f32_16x16x32_bf16 v[132:135], v[100:103], v[56:59], v[132:135]
    v_mov_b32_dpp v184, v180 quad_perm:[0,0,0,0] row_mask:0xf bank_mask:0xf
    v_mov_b32_dpp v185, v181 quad_perm:[0,0,0,0] row_mask:0xf bank_mask:0xf
    v_mfma_f32_16x16x32_bf16 v[136:139], v[112:115], v[56:59], v[136:139]
    v_mov_b32_dpp v186, v180 quad_perm:[1,1,1,1] row_mask:0xf bank_mask:0xf
    v_mov_b32_dpp v187, v181 quad_perm:[1,1,1,1] row_mask:0xf bank_mask:0xf
    v_mfma_f32_16x16x32_bf16 v[140:143], v[124:127], v[56:59], v[140:143]
    v_mov_b32_dpp v188, v180 quad_perm:[2,2,2,2] row_mask:0xf bank_mask:0xf
    v_mov_b32_dpp v189, v181 quad_perm:[2,2,2,2] row_mask:0xf bank_mask:0xf
    v_mfma_f32_16x16x32_bf16 v[144:147], v[28:31], v[56:59], v[144:147]
    v_mov_b32_dpp v190, v180 quad_perm:[3,3,3,3] row_mask:0xf bank_mask:0xf
    v_mov_b32_dpp v191, v181 quad_perm:[3,3,3,3] row_mask:0xf bank_mask:0xf
    v_mfma_f32_16x16x32_bf16 v[132:135], v[104:107], v[64:67], v[132:135]
    v_mfma_f32_16x16x32_bf16 v[136:139], v[116:119], v[64:67], v[136:139]
    v_mfma_f32_16x16x32_bf16 v[140:143], v[128:131], v[64:67], v[140:143]
    v_mfma_f32_16x16x32_bf16 v[144:147], v[32:35], v[64:67], v[144:147]
    v_mfma_f32_16x16x32_bf16 v[148:151], v[96:99], v[72:75], 0
    v_mfma_f32_16x16x32_bf16 v[148:151], v[100:103], v[80:83], v[148:151]
    v_mfma_f32_16x16x32_bf16 v[148:151], v[104:107], v[88:91], v[148:151]
    v_mfma_f32_16x16x32_bf16 v[152:155], v[108:111], v[72:75], 0
    v_mfma_f32_16x16x32_bf16 v[152:155], v[112:115], v[80:83], v[152:155]
    v_mfma_f32_16x16x32_bf16 v[152:155], v[116:119], v[88:91], v[152:155]
    v_mfma_f32_16x16x32_bf16 v[156:159], v[120:123], v[72:75], 0
    s_nop 0
    v_max3_f32 v145, v132, v133, v134
    v_mfma_f32_16x16x32_bf16 v[156:159], v[124:127], v[80:83], v[156:159]
    v_max3_f32 v145, v145, v135, v136
    v_max3_f32 v145, v145, v137, v138
    v_mfma_f32_16x16x32_bf16 v[156:159], v[128:131], v[88:91], v[156:159]
    v_max3_f32 v145, v145, v139, v140
    v_max3_f32 v145, v145, v141, v142
    v_mfma_f32_16x16x32_bf16 v[160:163], v[24:27], v[72:75], v[4:7]
    v_max3_f32 v145, v145, v143, v144
    v_mov_b32 v146, v145
    v_mfma_f32_16x16x32_bf16 v[160:163], v[28:31], v[80:83], v[160:163]
    s_nop 0
    v_permlane32_swap_b32 v145, v146
    v_mfma_f32_16x16x32_bf16 v[160:163], v[32:35], v[88:91], v[160:163]
    v_max_f32 v145, v145, v146
    v_mov_b32 v146, v145
    v_mfma_f32_16x16x32_bf16 v[164:167], v[96:99], v[196:199], 0
    s_nop 0
    v_permlane16_swap_b32 v145, v146
    v_mfma_f32_16x16x32_bf16 v[164:167], v[100:103], v[200:203], v[164:167]
    v_max_f32 v145, v145, v146
    v_sub_f32 v132, v132, v145
    v_mfma_f32_16x16x32_bf16 v[164:167], v[104:107], v[204:207], v[164:167]
    v_sub_f32 v133, v133, v145
    v_sub_f32 v134, v134, v145
    v_mfma_f32_16x16x32_bf16 v[168:171], v[108:111], v[196:199], 0
    v_sub_f32 v135, v135, v145
    v_sub_f32 v136, v136, v145
    v_mfma_f32_16x16x32_bf16 v[168:171], v[112:115], v[200:203], v[168:171]
    v_sub_f32 v137, v137, v145
    v_sub_f32 v138, v138, v145
    v_mfma_f32_16x16x32_bf16 v[168:171], v[116:119], v[204:207], v[168:171]
    v_sub_f32 v139, v139, v145
    v_sub_f32 v140, v140, v145
    v_mfma_f32_16x16x32_bf16 v[172:175], v[120:123], v[196:199], 0
    v_sub_f32 v141, v141, v145
    v_sub_f32 v142, v142, v145
    v_mfma_f32_16x16x32_bf16 v[172:175], v[124:127], v[200:203], v[172:175]
    v_sub_f32 v143, v143, v145
    v_sub_f32 v144, v144, v145
    v_mfma_f32_16x16x32_bf16 v[172:175], v[128:131], v[204:207], v[172:175]
    v_exp_f32 v132, v132
    v_mfma_f32_16x16x32_bf16 v[176:179], v[24:27], v[196:199], v[4:7]
    v_exp_f32 v133, v133
    v_mfma_f32_16x16x32_bf16 v[176:179], v[28:31], v[200:203], v[176:179]
    v_exp_f32 v134, v134
    v_mfma_f32_16x16x32_bf16 v[176:179], v[32:35], v[204:207], v[176:179]
    v_add_f32 v147, v132, v133
    v_exp_f32 v135, v135
    s_waitcnt lgkmcnt(3)
    v_mfma_f32_16x16x32_bf16 v[208:211], v[96:99], v[232:235], 0
    v_add_f32 v147, v147, v134
    v_exp_f32 v136, v136
    v_mfma_f32_16x16x32_bf16 v[208:211], v[100:103], v[236:239], v[208:211]
    v_add_f32 v147, v147, v135
    v_exp_f32 v137, v137
    v_mfma_f32_16x16x32_bf16 v[208:211], v[104:107], v[240:243], v[208:211]
    v_add_f32 v147, v147, v136
    v_exp_f32 v138, v138
    v_mfma_f32_16x16x32_bf16 v[212:215], v[108:111], v[232:235], 0
    v_add_f32 v147, v147, v137
    v_exp_f32 v139, v139
    v_mfma_f32_16x16x32_bf16 v[212:215], v[112:115], v[236:239], v[212:215]
    v_add_f32 v147, v147, v138
    v_exp_f32 v140, v140
    v_mfma_f32_16x16x32_bf16 v[212:215], v[116:119], v[240:243], v[212:215]
    v_cvt_pk_bf16_f32 v48, v208, v209
    v_cvt_pk_bf16_f32 v49, v210, v211
    v_mfma_f32_16x16x32_bf16 v[216:219], v[120:123], v[232:235], 0
    ds_read_b128 v[232:235], v6 offset:24672
    v_add_f32 v147, v147, v139
    v_mfma_f32_16x16x32_bf16 v[216:219], v[124:127], v[236:239], v[216:219]
    ds_read_b128 v[236:239], v6 offset:25696
    v_exp_f32 v141, v141
    v_mfma_f32_16x16x32_bf16 v[216:219], v[128:131], v[240:243], v[216:219]
    ds_read_b128 v[240:243], v6 offset:26720
    v_cvt_pk_bf16_f32 v50, v212, v213
    s_waitcnt lgkmcnt(3)
    v_mfma_f32_16x16x32_bf16 v[220:223], v[96:99], v[244:247], 0
    v_cvt_pk_bf16_f32 v51, v214, v215
    v_add_f32 v147, v147, v140
    v_mfma_f32_16x16x32_bf16 v[220:223], v[100:103], v[248:251], v[220:223]
    v_exp_f32 v142, v142
    v_mfma_f32_16x16x32_bf16 v[220:223], v[104:107], v[252:255], v[220:223]
    v_cvt_pk_bf16_f32 v52, v216, v217
    v_cvt_pk_bf16_f32 v53, v218, v219
    v_mfma_f32_16x16x32_bf16 v[224:227], v[108:111], v[244:247], 0
    v_add_f32 v147, v147, v141
    v_exp_f32 v143, v143
    v_mfma_f32_16x16x32_bf16 v[224:227], v[112:115], v[248:251], v[224:227]
    v_add_f32 v147, v147, v142
    v_exp_f32 v144, v144
    v_mfma_f32_16x16x32_bf16 v[224:227], v[116:119], v[252:255], v[224:227]
    v_cvt_pk_bf16_f32 v56, v220, v221
    v_cvt_pk_bf16_f32 v57, v222, v223
    v_mfma_f32_16x16x32_bf16 v[228:231], v[120:123], v[244:247], 0
    ds_read_b128 v[244:247], v6 offset:27792
    v_add_f32 v147, v147, v143
    v_mfma_f32_16x16x32_bf16 v[228:231], v[124:127], v[248:251], v[228:231]
    ds_read_b128 v[248:251], v6 offset:28816
    v_add_f32 v147, v147, v144
    v_mfma_f32_16x16x32_bf16 v[228:231], v[128:131], v[252:255], v[228:231]
    ds_read_b128 v[252:255], v6 offset:29840
    v_cvt_pk_bf16_f32 v58, v224, v225
    s_waitcnt lgkmcnt(3)
    v_mfma_f32_16x16x32_bf16 v[208:211], v[96:99], v[232:235], 0
    v_cvt_pk_bf16_f32 v59, v226, v227
    v_mov_b32 v146, v147
    v_mfma_f32_16x16x32_bf16 v[208:211], v[100:103], v[236:239], v[208:211]
    v_max3_f32 v161, v148, v149, v150
    v_permlane32_swap_b32 v147, v146
    v_mfma_f32_16x16x32_bf16 v[208:211], v[104:107], v[240:243], v[208:211]
    v_cvt_pk_bf16_f32 v60, v228, v229
    v_cvt_pk_bf16_f32 v61, v230, v231
    v_mfma_f32_16x16x32_bf16 v[212:215], v[108:111], v[232:235], 0
    v_add_f32 v147, v147, v146
    v_mov_b32 v146, v147
    v_mfma_f32_16x16x32_bf16 v[212:215], v[112:115], v[236:239], v[212:215]
    v_max3_f32 v161, v161, v151, v152
    v_permlane16_swap_b32 v147, v146
    v_mfma_f32_16x16x32_bf16 v[212:215], v[116:119], v[240:243], v[212:215]
    v_cvt_pk_bf16_f32 v64, v208, v209
    v_cvt_pk_bf16_f32 v65, v210, v211
    v_mfma_f32_16x16x32_bf16 v[216:219], v[120:123], v[232:235], 0
    ds_read_b128 v[232:235], v6 offset:30912
    v_add_f32 v147, v147, v146
    v_mfma_f32_16x16x32_bf16 v[216:219], v[124:127], v[236:239], v[216:219]
    ds_read_b128 v[236:239], v6 offset:31936
    v_rcp_f32 v145, v147
    v_mfma_f32_16x16x32_bf16 v[216:219], v[128:131], v[240:243], v[216:219]
    ds_read_b128 v[240:243], v6 offset:32960
    v_cvt_pk_bf16_f32 v66, v212, v213
    s_waitcnt lgkmcnt(3)
    v_mfma_f32_16x16x32_bf16 v[220:223], v[96:99], v[244:247], 0
    v_cvt_pk_bf16_f32 v67, v214, v215
    v_mul_f32 v132, v132, v145
    v_mfma_f32_16x16x32_bf16 v[220:223], v[100:103], v[248:251], v[220:223]
    v_mul_f32 v133, v133, v145
    v_cvt_pk_bf16_f32 v132, v132, v133
    v_mfma_f32_16x16x32_bf16 v[220:223], v[104:107], v[252:255], v[220:223]
    v_cvt_pk_bf16_f32 v68, v216, v217
    v_cvt_pk_bf16_f32 v69, v218, v219
    v_mfma_f32_16x16x32_bf16 v[224:227], v[108:111], v[244:247], 0
    v_mul_f32 v134, v134, v145
    v_mul_f32 v135, v135, v145
    v_mfma_f32_16x16x32_bf16 v[224:227], v[112:115], v[248:251], v[224:227]
    v_cvt_pk_bf16_f32 v133, v134, v135
    v_mul_f32 v136, v136, v145
    v_mfma_f32_16x16x32_bf16 v[224:227], v[116:119], v[252:255], v[224:227]
    v_cvt_pk_bf16_f32 v72, v220, v221
    v_cvt_pk_bf16_f32 v73, v222, v223
    v_mfma_f32_16x16x32_bf16 v[228:231], v[120:123], v[244:247], 0
    ds_read_b128 v[244:247], v6 offset:34032
    v_mul_f32 v137, v137, v145
    v_mfma_f32_16x16x32_bf16 v[228:231], v[124:127], v[248:251], v[228:231]
    ds_read_b128 v[248:251], v6 offset:35056
    v_cvt_pk_bf16_f32 v134, v136, v137
    v_mfma_f32_16x16x32_bf16 v[228:231], v[128:131], v[252:255], v[228:231]
    ds_read_b128 v[252:255], v6 offset:36080
    v_cvt_pk_bf16_f32 v74, v224, v225
    s_waitcnt lgkmcnt(3)
    v_mfma_f32_16x16x32_bf16 v[208:211], v[96:99], v[232:235], 0
    v_cvt_pk_bf16_f32 v75, v226, v227
    v_mul_f32 v138, v138, v145
    v_mfma_f32_16x16x32_bf16 v[208:211], v[100:103], v[236:239], v[208:211]
    v_mul_f32 v139, v139, v145
    v_cvt_pk_bf16_f32 v135, v138, v139
    v_mfma_f32_16x16x32_bf16 v[208:211], v[104:107], v[240:243], v[208:211]
    v_cvt_pk_bf16_f32 v76, v228, v229
    v_cvt_pk_bf16_f32 v77, v230, v231
    v_mfma_f32_16x16x32_bf16 v[212:215], v[108:111], v[232:235], 0
    v_mul_f32 v140, v140, v145
    v_mul_f32 v141, v141, v145
    v_mfma_f32_16x16x32_bf16 v[212:215], v[112:115], v[236:239], v[212:215]
    v_cvt_pk_bf16_f32 v136, v140, v141
    v_mul_f32 v142, v142, v145
    v_mfma_f32_16x16x32_bf16 v[212:215], v[116:119], v[240:243], v[212:215]
    v_cvt_pk_bf16_f32 v80, v208, v209
    v_cvt_pk_bf16_f32 v81, v210, v211
    v_mfma_f32_16x16x32_bf16 v[216:219], v[120:123], v[232:235], 0
    v_mul_f32 v143, v143, v145
    v_cvt_pk_bf16_f32 v137, v142, v143
    v_mfma_f32_16x16x32_bf16 v[216:219], v[124:127], v[236:239], v[216:219]
    v_mul_f32 v144, v144, v145
    v_cvt_pk_bf16_f32 v138, v144, 0
    v_mfma_f32_16x16x32_bf16 v[216:219], v[128:131], v[240:243], v[216:219]
    v_cvt_pk_bf16_f32 v82, v212, v213
    v_cvt_pk_bf16_f32 v83, v214, v215
    s_waitcnt lgkmcnt(0)
    v_mfma_f32_16x16x32_bf16 v[220:223], v[96:99], v[244:247], 0
    v_mov_b32 v139, 0
    v_max3_f32 v161, v161, v153, v154
    v_mfma_f32_16x16x32_bf16 v[220:223], v[100:103], v[248:251], v[220:223]
    v_max3_f32 v161, v161, v155, v156
    v_max3_f32 v161, v161, v157, v158
    v_mfma_f32_16x16x32_bf16 v[220:223], v[104:107], v[252:255], v[220:223]
    v_cvt_pk_bf16_f32 v84, v216, v217
    v_cvt_pk_bf16_f32 v85, v218, v219
    v_mfma_f32_16x16x32_bf16 v[224:227], v[108:111], v[244:247], 0
    v_max3_f32 v161, v161, v159, v160
    v_mov_b32 v162, v161
    v_mfma_f32_16x16x32_bf16 v[224:227], v[112:115], v[248:251], v[224:227]
    v_max3_f32 v177, v164, v165, v166
    v_permlane32_swap_b32 v161, v162
    v_mfma_f32_16x16x32_bf16 v[224:227], v[116:119], v[252:255], v[224:227]
    v_cvt_pk_bf16_f32 v88, v220, v221
    v_cvt_pk_bf16_f32 v89, v222, v223
    v_mfma_f32_16x16x32_bf16 v[228:231], v[120:123], v[244:247], 0
    v_max_f32 v161, v161, v162
    v_mov_b32 v162, v161
    v_mfma_f32_16x16x32_bf16 v[228:231], v[124:127], v[248:251], v[228:231]
    v_max3_f32 v177, v177, v167, v168
    v_permlane16_swap_b32 v161, v162
    v_mfma_f32_16x16x32_bf16 v[228:231], v[128:131], v[252:255], v[228:231]
    v_cvt_pk_bf16_f32 v90, v224, v225
    v_cvt_pk_bf16_f32 v91, v226, v227
    v_mfma_f32_16x16x32_bf16 v[196:199], v[184:187], v[48:51], 0
    v_max_f32 v161, v161, v162
    v_sub_f32 v148, v148, v161
    v_mfma_f32_16x16x32_bf16 v[196:199], v[188:191], v[52:55], v[196:199]
    v_sub_f32 v149, v149, v161
    v_sub_f32 v150, v150, v161
    v_mfma_f32_16x16x32_bf16 v[200:203], v[184:187], v[56:59], 0
    v_cvt_pk_bf16_f32 v92, v228, v229
    v_cvt_pk_bf16_f32 v93, v230, v231
    v_mfma_f32_16x16x32_bf16 v[200:203], v[188:191], v[60:63], v[200:203]
    v_sub_f32 v151, v151, v161
    v_sub_f32 v152, v152, v161
    v_mfma_f32_16x16x32_bf16 v[204:207], v[184:187], v[64:67], 0
    v_sub_f32 v153, v153, v161
    v_sub_f32 v154, v154, v161
    v_mfma_f32_16x16x32_bf16 v[204:207], v[188:191], v[68:71], v[204:207]
    v_sub_f32 v155, v155, v161
    v_sub_f32 v156, v156, v161
    v_mfma_f32_16x16x32_bf16 v[244:247], v[184:187], v[72:75], 0
    v_sub_f32 v157, v157, v161
    v_sub_f32 v158, v158, v161
    v_mfma_f32_16x16x32_bf16 v[244:247], v[188:191], v[76:79], v[244:247]
    v_sub_f32 v159, v159, v161
    v_sub_f32 v160, v160, v161
    v_mfma_f32_16x16x32_bf16 v[248:251], v[184:187], v[80:83], 0
    v_exp_f32 v148, v148
    v_mfma_f32_16x16x32_bf16 v[248:251], v[188:191], v[84:87], v[248:251]
    v_exp_f32 v149, v149
    v_mfma_f32_16x16x32_bf16 v[252:255], v[184:187], v[88:91], 0
    v_exp_f32 v150, v150
    v_mfma_f32_16x16x32_bf16 v[252:255], v[188:191], v[92:95], v[252:255]
    v_add_f32 v163, v148, v149
    v_exp_f32 v151, v151
    v_mfma_f32_16x16x32_bf16 v[208:211], v[132:135], v[48:51], 0
    v_add_f32 v163, v163, v150
    v_exp_f32 v152, v152
    v_mfma_f32_16x16x32_bf16 v[208:211], v[136:139], v[52:55], v[208:211]
    v_add_f32 v163, v163, v151
    v_exp_f32 v153, v153
    v_mfma_f32_16x16x32_bf16 v[212:215], v[132:135], v[56:59], 0
    v_add_f32 v163, v163, v152
    v_exp_f32 v154, v154
    v_mfma_f32_16x16x32_bf16 v[212:215], v[136:139], v[60:63], v[212:215]
    v_add_f32 v163, v163, v153
    v_exp_f32 v155, v155
    v_mfma_f32_16x16x32_bf16 v[216:219], v[132:135], v[64:67], 0
    v_add_f32 v163, v163, v154
    v_exp_f32 v156, v156
    v_mfma_f32_16x16x32_bf16 v[216:219], v[136:139], v[68:71], v[216:219]
    v_add_f32 v163, v163, v155
    v_exp_f32 v157, v157
    v_mfma_f32_16x16x32_bf16 v[220:223], v[132:135], v[72:75], 0
    v_add_f32 v163, v163, v156
    v_exp_f32 v158, v158
    v_mfma_f32_16x16x32_bf16 v[220:223], v[136:139], v[76:79], v[220:223]
    v_add_f32 v163, v163, v157
    v_exp_f32 v159, v159
    v_mfma_f32_16x16x32_bf16 v[224:227], v[132:135], v[80:83], 0
    v_add_f32 v163, v163, v158
    v_exp_f32 v160, v160
    v_mfma_f32_16x16x32_bf16 v[224:227], v[136:139], v[84:87], v[224:227]
    v_add_f32 v163, v163, v159
    v_add_f32 v163, v163, v160
    v_mfma_f32_16x16x32_bf16 v[228:231], v[132:135], v[88:91], 0
    v_mov_b32 v162, v163
    v_max3_f32 v177, v177, v169, v170
    v_mfma_f32_16x16x32_bf16 v[228:231], v[136:139], v[92:95], v[228:231]
    v_permlane32_swap_b32 v163, v162
    v_add_f32 v163, v163, v162
    v_mov_b32 v162, v163
    v_max3_f32 v177, v177, v171, v172
    v_max3_f32 v177, v177, v173, v174
    v_permlane16_swap_b32 v163, v162
    v_add_f32 v163, v163, v162
    v_rcp_f32 v161, v163
    v_max3_f32 v177, v177, v175, v176
    v_mul_f32 v148, v148, v161
    v_mul_f32 v149, v149, v161
    v_cvt_pk_bf16_f32 v148, v148, v149
    v_mul_f32 v150, v150, v161
    v_mul_f32 v151, v151, v161
    v_cvt_pk_bf16_f32 v149, v150, v151
    v_mul_f32 v152, v152, v161
    v_mul_f32 v153, v153, v161
    v_cvt_pk_bf16_f32 v150, v152, v153
    v_mul_f32 v154, v154, v161
    v_mul_f32 v155, v155, v161
    v_cvt_pk_bf16_f32 v151, v154, v155
    v_mul_f32 v156, v156, v161
    v_mul_f32 v157, v157, v161
    v_cvt_pk_bf16_f32 v152, v156, v157
    v_mul_f32 v158, v158, v161
    v_mul_f32 v159, v159, v161
    v_cvt_pk_bf16_f32 v153, v158, v159
    v_mul_f32 v160, v160, v161
    v_cvt_pk_bf16_f32 v154, v160, 0
    v_mov_b32 v155, 0
    v_mov_b32 v178, v177
    v_cvt_pk_bf16_f32 v180, v196, v200
    v_mfma_f32_16x16x32_bf16 v[196:199], v[148:151], v[48:51], 0
    v_permlane32_swap_b32 v177, v178
    v_max_f32 v177, v177, v178
    v_mfma_f32_16x16x32_bf16 v[196:199], v[152:155], v[52:55], v[196:199]
    v_mov_b32 v178, v177
    v_cvt_pk_bf16_f32 v181, v204, v244
    v_mfma_f32_16x16x32_bf16 v[200:203], v[148:151], v[56:59], 0
    v_permlane16_swap_b32 v177, v178
    v_max_f32 v177, v177, v178
    v_mfma_f32_16x16x32_bf16 v[200:203], v[152:155], v[60:63], v[200:203]
    v_sub_f32 v164, v164, v177
    v_sub_f32 v165, v165, v177
    v_mfma_f32_16x16x32_bf16 v[204:207], v[148:151], v[64:67], 0
    v_sub_f32 v166, v166, v177
    v_sub_f32 v167, v167, v177
    v_mfma_f32_16x16x32_bf16 v[204:207], v[152:155], v[68:71], v[204:207]
    v_sub_f32 v168, v168, v177
    v_sub_f32 v169, v169, v177
    v_mfma_f32_16x16x32_bf16 v[244:247], v[148:151], v[72:75], 0
    v_sub_f32 v170, v170, v177
    v_sub_f32 v171, v171, v177
    v_mfma_f32_16x16x32_bf16 v[244:247], v[152:155], v[76:79], v[244:247]
    v_sub_f32 v172, v172, v177
    v_sub_f32 v173, v173, v177
    v_sub_f32 v174, v174, v177
    v_sub_f32 v175, v175, v177
    v_sub_f32 v176, v176, v177
    v_exp_f32 v164, v164
    v_exp_f32 v165, v165
    v_exp_f32 v166, v166
    v_add_f32 v179, v164, v165
    v_exp_f32 v167, v167
    v_add_f32 v179, v179, v166
    v_exp_f32 v168, v168
    v_add_f32 v179, v179, v167
    v_exp_f32 v169, v169
    v_add_f32 v179, v179, v168
    v_exp_f32 v170, v170
    v_add_f32 v179, v179, v169
    v_exp_f32 v171, v171
    v_add_f32 v179, v179, v170
    v_exp_f32 v172, v172
    v_add_f32 v179, v179, v171
    v_exp_f32 v173, v173
    v_add_f32 v179, v179, v172
    v_exp_f32 v174, v174
    v_add_f32 v179, v179, v173
    v_exp_f32 v175, v175
    v_add_f32 v179, v179, v174
    v_exp_f32 v176, v176
    v_add_f32 v179, v179, v175
    v_add_f32 v179, v179, v176
    v_mov_b32 v178, v179
    v_cvt_pk_bf16_f32 v182, v248, v252
    v_mfma_f32_16x16x32_bf16 v[248:251], v[148:151], v[80:83], 0
    s_mov_b64 exec, s[42:43]
    buffer_store_dwordx3 v[180:182], v8, s[16:19], s41 offen offset:1152 sc1
    s_mov_b64 exec, -1
    v_mfma_f32_16x16x32_bf16 v[248:251], v[152:155], v[84:87], v[248:251]
    v_permlane32_swap_b32 v179, v178
    v_add_f32 v179, v179, v178
    v_mfma_f32_16x16x32_bf16 v[252:255], v[148:151], v[88:91], 0
    v_mov_b32 v178, v179
    v_cvt_pk_bf16_f32 v140, v208, v212
    v_mfma_f32_16x16x32_bf16 v[252:255], v[152:155], v[92:95], v[252:255]
    v_permlane16_swap_b32 v179, v178
    v_add_f32 v179, v179, v178
    v_rcp_f32 v177, v179
    v_cvt_pk_bf16_f32 v141, v216, v220
    v_mul_f32 v164, v164, v177
    v_mul_f32 v165, v165, v177
    v_cvt_pk_bf16_f32 v164, v164, v165
    v_mul_f32 v166, v166, v177
    v_mul_f32 v167, v167, v177
    v_cvt_pk_bf16_f32 v165, v166, v167
    v_mul_f32 v168, v168, v177
    v_mul_f32 v169, v169, v177
    v_cvt_pk_bf16_f32 v166, v168, v169
    v_mul_f32 v170, v170, v177
    v_mul_f32 v171, v171, v177
    v_cvt_pk_bf16_f32 v167, v170, v171
    v_mul_f32 v172, v172, v177
    v_mul_f32 v173, v173, v177
    v_cvt_pk_bf16_f32 v168, v172, v173
    v_mul_f32 v174, v174, v177
    v_mul_f32 v175, v175, v177
    v_cvt_pk_bf16_f32 v169, v174, v175
    v_mul_f32 v176, v176, v177
    v_cvt_pk_bf16_f32 v170, v176, 0
    v_mov_b32 v171, 0
    v_cvt_pk_bf16_f32 v142, v224, v228
    buffer_store_dwordx3 v[140:142], v8, s[16:19], s34 offen sc1
    v_cvt_pk_bf16_f32 v144, v209, v213
    v_cvt_pk_bf16_f32 v145, v217, v221
    v_cvt_pk_bf16_f32 v146, v225, v229
    buffer_store_dwordx3 v[144:146], v11, s[16:19], s34 offen offset:768 sc1
    v_cvt_pk_bf16_f32 v140, v210, v214
    v_cvt_pk_bf16_f32 v141, v218, v222
    v_cvt_pk_bf16_f32 v142, v226, v230
    buffer_store_dwordx3 v[140:142], v8, s[16:19], s35 offen offset:192 sc1
    v_cvt_pk_bf16_f32 v144, v211, v215
    v_mfma_f32_16x16x32_bf16 v[208:211], v[164:167], v[48:51], 0
    v_cvt_pk_bf16_f32 v145, v219, v223
    v_cvt_pk_bf16_f32 v146, v227, v231
    v_mfma_f32_16x16x32_bf16 v[208:211], v[168:171], v[52:55], v[208:211]
    buffer_store_dwordx3 v[144:146], v10, s[16:19], s35 offen offset:960 sc1
    v_mfma_f32_16x16x32_bf16 v[212:215], v[164:167], v[56:59], 0
    v_cvt_pk_bf16_f32 v156, v196, v200
    v_cvt_pk_bf16_f32 v157, v204, v244
    v_mfma_f32_16x16x32_bf16 v[212:215], v[168:171], v[60:63], v[212:215]
    v_cvt_pk_bf16_f32 v158, v248, v252
    buffer_store_dwordx3 v[156:158], v8, s[16:19], s36 offen offset:384 sc1
    v_mfma_f32_16x16x32_bf16 v[216:219], v[164:167], v[64:67], 0
    v_cvt_pk_bf16_f32 v160, v197, v201
    v_cvt_pk_bf16_f32 v161, v205, v245
    v_mfma_f32_16x16x32_bf16 v[216:219], v[168:171], v[68:71], v[216:219]
    v_cvt_pk_bf16_f32 v162, v249, v253
    buffer_store_dwordx3 v[160:162], v9, s[16:19], s36 offen offset:1152 sc1
    v_mfma_f32_16x16x32_bf16 v[220:223], v[164:167], v[72:75], 0
    v_cvt_pk_bf16_f32 v140, v198, v202
    v_cvt_pk_bf16_f32 v141, v206, v246
    v_mfma_f32_16x16x32_bf16 v[220:223], v[168:171], v[76:79], v[220:223]
    v_cvt_pk_bf16_f32 v142, v250, v254
    buffer_store_dwordx3 v[140:142], v8, s[16:19], s37 offen offset:576 sc1
    v_mfma_f32_16x16x32_bf16 v[224:227], v[164:167], v[80:83], 0
    v_cvt_pk_bf16_f32 v144, v199, v203
    v_cvt_pk_bf16_f32 v145, v207, v247
    v_mfma_f32_16x16x32_bf16 v[224:227], v[168:171], v[84:87], v[224:227]
    v_cvt_pk_bf16_f32 v146, v251, v255
    buffer_store_dwordx3 v[144:146], v8, s[16:19], s38 offen sc1
    v_mfma_f32_16x16x32_bf16 v[228:231], v[164:167], v[88:91], 0
    v_cvt_pk_bf16_f32 v172, v208, v212
    v_cvt_pk_bf16_f32 v173, v216, v220
    v_mfma_f32_16x16x32_bf16 v[228:231], v[168:171], v[92:95], v[228:231]
    v_cvt_pk_bf16_f32 v176, v209, v213
    v_cvt_pk_bf16_f32 v177, v217, v221
    v_cvt_pk_bf16_f32 v156, v210, v214
    v_cvt_pk_bf16_f32 v157, v218, v222
    v_cvt_pk_bf16_f32 v160, v211, v215
    v_cvt_pk_bf16_f32 v161, v219, v223
    ds_read_b128 v[96:99], v5 offset:0
    ds_read_b128 v[100:103], v5 offset:64
    v_cvt_pk_bf16_f32 v174, v224, v228
    buffer_store_dwordx3 v[172:174], v11, s[16:19], s38 offen offset:768 sc1
    v_cvt_pk_bf16_f32 v178, v225, v229
    buffer_store_dwordx3 v[176:178], v8, s[16:19], s39 offen offset:192 sc1
    v_cvt_pk_bf16_f32 v158, v226, v230
    buffer_store_dwordx3 v[156:158], v10, s[16:19], s39 offen offset:960 sc1
    v_cvt_pk_bf16_f32 v162, v227, v231
    buffer_store_dwordx3 v[160:162], v8, s[16:19], s40 offen offset:384 sc1
    ds_read_b128 v[104:107], v5 offset:128
    ds_read_b128 v[108:111], v5 offset:3072
    ds_read_b128 v[112:115], v5 offset:3136
    ds_read_b128 v[116:119], v5 offset:3200
    ds_read_b128 v[120:123], v5 offset:6144
    ds_read_b128 v[124:127], v5 offset:6208
    ds_read_b128 v[128:131], v5 offset:6272
    ds_read_b128 v[232:235], v6 offset:0
    ds_read_b128 v[236:239], v6 offset:1024
    ds_read_b128 v[240:243], v6 offset:2048
    s_nop 7
    s_branch L_cont
.section .rodata,"a"
.p2align 6
.amdhsa_kernel standalone__swin_window_attn__vision_kernel
  .amdhsa_next_free_vgpr 256
  .amdhsa_next_free_sgpr 80
  .amdhsa_accum_offset 256
  .amdhsa_group_segment_fixed_size 0
  .amdhsa_kernarg_size 48
  .amdhsa_user_sgpr_count 2
  .amdhsa_user_sgpr_kernarg_segment_ptr 1
  .amdhsa_system_sgpr_workgroup_id_x 1
.end_amdhsa_kernel
```
